```python
import torch

def _softmax(x, axis=-1):
    return torch.softmax(x, dim=axis)
def _gelu(x):
    return torch.nn.functional.gelu(x, approximate="tanh")
def _silu(x):
    return torch.nn.functional.silu(x)
def _sigmoid(x):
    return torch.sigmoid(x)
def _layernorm(x, axis=-1, eps=1e-5):
    m = x.mean(dim=axis, keepdim=True)
    v = x.var(dim=axis, keepdim=True, unbiased=False)
    return (x - m) / torch.sqrt(v + eps)
def _scatter_add(tgt, idx, src, axis=0):
    return tgt.clone().index_add_(axis, idx, src)
def _segment_sum(src, seg, n):
    out = torch.zeros((n,) + src.shape[1:], dtype=src.dtype)
    return out.index_add_(0, seg, src)
def _pad(x, pw):
    flat = tuple(v for pair in reversed(pw) for v in pair)
    return torch.nn.functional.pad(x, flat)

kernel_name = 'concat_heads__mha_block_cached__gqa_block_cached__near_ridge'

def setup_inputs():

    _w = (lambda a: (lambda t: t.to(torch.bfloat16) if t.is_floating_point() else t)(torch.as_tensor(a)))
    def _A_setup():
        B, Sq, D = 8, 128, 576
        H, Sk, Dh = 32, 128, 128
        return {
            "x": _w((lambda *s: torch.randn(*s, dtype=torch.bfloat16) * 0.8)(B, Sq, D)),
            "k_cache": _w((lambda *s: torch.randn(*s, dtype=torch.bfloat16) * 0.8)(B, H, Sk, Dh)),
            "v_cache": _w((lambda *s: torch.randn(*s, dtype=torch.bfloat16) * 0.05)(B, H, Sk, Dh)),
            "wq": _w((lambda *s: torch.randn(*s, dtype=torch.bfloat16) * 0.8)(D, H * Dh) * (D ** -0.5)),
            "wo": _w((lambda *s: torch.randn(*s, dtype=torch.bfloat16) * 0.05)(H * Dh, D) * ((H * Dh) ** -0.5)),
        }
    _A_in = _A_setup()

    def _B_setup():
        B, Sq, D = 8, 128, 576
        Hq, Hkv, Sk, Dh = 32, 32, 128, 128
        assert Hq % Hkv == 0, (Hq, Hkv)
        return {
            "x": _w((lambda *s: torch.randn(*s, dtype=torch.bfloat16) * 0.8)(B, Sq, D)),
            "k_cache": _w((lambda *s: torch.randn(*s, dtype=torch.bfloat16) * 0.8)(B, Hkv, Sk, Dh)),
            "v_cache": _w((lambda *s: torch.randn(*s, dtype=torch.bfloat16) * 0.05)(B, Hkv, Sk, Dh)),
            "wq": _w((lambda *s: torch.randn(*s, dtype=torch.bfloat16) * 0.8)(D, Hq * Dh) * (D ** -0.5)),
            "wo": _w((lambda *s: torch.randn(*s, dtype=torch.bfloat16) * 0.05)(Hq * Dh, D) * ((Hq * Dh) ** -0.5)),
        }
    _B_in = _B_setup()

    return {
        "A_x": _A_in["x"],
        "A_k_cache": _A_in["k_cache"],
        "A_v_cache": _A_in["v_cache"],
        "A_wq": _A_in["wq"],
        "A_wo": _A_in["wo"],
        "B_x": _B_in["x"],
        "B_k_cache": _B_in["k_cache"],
        "B_v_cache": _B_in["v_cache"],
        "B_wq": _B_in["wq"],
        "B_wo": _B_in["wo"],
    }

def reference(A_x, A_k_cache, A_v_cache, A_wq, A_wo, B_x, B_k_cache, B_v_cache, B_wq, B_wo):
    def _A_ref(x, k_cache, v_cache, wq, wo):
        B, Sq, D = x.shape
        H, Dh = 32, 128
        q = (lambda x, *d: x.permute(*d))((x @ wq).reshape(B, Sq, H, Dh), 0, 2, 1, 3)
        scores = torch.einsum("bhqd,bhkd->bhqk", q, k_cache) * (Dh ** -0.5)
        p = _softmax(scores, axis=-1)
        o = torch.einsum("bhqk,bhkd->bhqd", p, v_cache)
        return (lambda x, *d: x.permute(*d))(o, 0, 2, 1, 3).reshape(B, Sq, H * Dh) @ wo

    def _B_ref(x, k_cache, v_cache, wq, wo):
        B, Sq, D = x.shape
        Hq, Dh = 32, 128
        Hkv = k_cache.shape[1]
        rep = Hq // Hkv
        q = (lambda x, *d: x.permute(*d))((x @ wq).reshape(B, Sq, Hq, Dh), 0, 2, 1, 3)
        k = (lambda x, n, axis: torch.repeat_interleave(x, n, dim=axis))(k_cache, rep, axis=1)
        v = (lambda x, n, axis: torch.repeat_interleave(x, n, dim=axis))(v_cache, rep, axis=1)
        scores = torch.einsum("bhqd,bhkd->bhqk", q, k) * (Dh ** -0.5)
        p = _softmax(scores, axis=-1)
        o = torch.einsum("bhqk,bhkd->bhqd", p, v)
        return (lambda x, *d: x.permute(*d))(o, 0, 2, 1, 3).reshape(B, Sq, Hq * Dh) @ wo

    a = _A_ref(A_x, A_k_cache, A_v_cache, A_wq, A_wo)
    b = _B_ref(B_x, B_k_cache, B_v_cache, B_wq, B_wo)
    return torch.concatenate([a, b], axis=-1)
```

```asm
; @launch grid=(256,1,1) block=(512,1,1) lds=151552
.amdgcn_target "amdgcn-amd-amdhsa--gfx950"
.text
.globl concat_heads__mha_block_cached__gqa_block_cached__near_ridge_kernel
.p2align 8
.type concat_heads__mha_block_cached__gqa_block_cached__near_ridge_kernel,@function
concat_heads__mha_block_cached__gqa_block_cached__near_ridge_kernel:
s_cmp_ge_u32 s2, 256
s_cbranch_scc1 L_end
s_and_b32 s44, s2, 4
s_mul_i32 s44, s44, 10
s_add_u32 s46, s0, s44
s_addc_u32 s47, s1, 0
s_load_dwordx2 s[12:13], s[46:47], 0
s_load_dwordx2 s[24:25], s[46:47], 24
s_load_dwordx4 s[60:63], s[46:47], 8
s_load_dwordx2 s[28:29], s[46:47], 32
s_load_dwordx4 s[68:71], s[0:1], 80
s_load_dwordx2 s[32:33], s[0:1], 96
v_readfirstlane_b32 s3, v0
v_and_b32 v0, 63, v0
s_lshr_b32 s6, s2, 5
s_lshr_b32 s3, s3, 6
s_and_b32 s10, s3, 3
s_cmp_lt_u32 s3, 4
s_cbranch_scc1 L_cstub
v_bfe_u32 v5, v0, 2, 3
v_mul_u32_u24 v6, 1152, v5
v_lshrrev_b32 v3, 5, v0
v_lshl_add_u32 v6, v3, 6, v6
v_lshrrev_b32 v7, 2, v5
v_xor_b32 v7, v7, v0
v_and_b32 v7, 3, v7
v_lshl_add_u32 v8, v7, 4, v6
v_xor_b32 v7, 2, v7
v_lshl_add_u32 v9, v7, 4, v6
s_mul_i32 s44, s10, 36864
v_add_u32 v200, s44, v8
v_add_u32 v9, s44, v9
v_add_u32 v201, 8192, v9
v_add_u32 v202, 16384, v200
v_add_u32 v203, 24576, v9
s_lshl_b32 s98, s10, 12
s_mul_i32 s48, s6, 147456
s_mov_b32 s14, 1179648
s_mov_b32 s15, 0x20000

s_waitcnt lgkmcnt(0)
s_add_u32 m0, s98, 4096
s_add_u32 s99, s48, 0
buffer_load_dwordx4 v200, s[12:15], s99 offen offset:0 lds
buffer_load_dwordx4 v201, s[12:15], s99 offen offset:1024 lds
buffer_load_dwordx4 v202, s[12:15], s99 offen offset:2048 lds
buffer_load_dwordx4 v203, s[12:15], s99 offen offset:3072 lds
v_bfe_u32 v1, v0, 2, 2
v_and_b32 v2, 3, v0
v_lshlrev_b32 v4, 2, v0
v_and_b32 v4, 0xc0, v4
v_lshl_add_u32 v4, v2, 4, v4
s_and_b32 s44, s10, 1
s_lshl_b32 s44, s44, 17
s_lshr_b32 s45, s10, 1
s_lshl_b32 s45, s45, 8
s_add_u32 s44, s44, s45
v_lshl_add_u32 v204, v1, 13, v4
v_add_u32 v204, s44, v204
v_add_u32 v205, 31744, v204
v_add_u32 v206, 63488, v204
v_add_u32 v207, 95232, v204
s_and_b32 s5, s2, 3
s_bfe_u32 s7, s2, 0x20003
s_lshl_b32 s44, s5, 3
s_lshl_b32 s45, s7, 1
s_add_u32 s11, s44, s45
s_lshl_b32 s49, s11, 8
s_mov_b32 s26, 4718592
s_mov_b32 s27, 0x20000
s_add_u32 m0, s98, 20480
s_add_u32 s99, s49, 0
buffer_load_dwordx4 v204, s[24:27], s99 offen offset:0 lds
buffer_load_dwordx4 v205, s[24:27], s99 offen offset:1024 lds
buffer_load_dwordx4 v206, s[24:27], s99 offen offset:2048 lds
buffer_load_dwordx4 v207, s[24:27], s99 offen offset:3072 lds
s_getpc_b64 s[96:97]
L_pc1:
s_add_u32 s96, s96, L_ones-L_pc1
s_addc_u32 s97, s97, 0
v_mov_b32 v18, 0
s_lshl_b32 s95, s10, 3
s_bfe_u32 s55, s2, 0x20003
s_lshl_b32 s55, s55, 1
s_add_u32 s55, s55, s6
s_sub_u32 s44, s55, 8
s_cmp_ge_u32 s55, 8
s_cselect_b32 s55, s44, s55
s_barrier
s_add_u32 m0, s95, 0
s_mov_b64 exec, 3
global_load_lds_dword v18, s[96:97]
s_mov_b64 exec, -1
s_add_u32 m0, s98, 36864
s_add_u32 s99, s49, 262144
buffer_load_dwordx4 v204, s[24:27], s99 offen offset:0 lds
buffer_load_dwordx4 v205, s[24:27], s99 offen offset:1024 lds
buffer_load_dwordx4 v206, s[24:27], s99 offen offset:2048 lds
buffer_load_dwordx4 v207, s[24:27], s99 offen offset:3072 lds
s_add_u32 m0, s95, 32
s_mov_b64 exec, 3
global_load_lds_dword v18, s[96:97]
s_mov_b64 exec, -1
s_branch L_lrest
L_cstub:
s_getpc_b64 s[96:97]
L_pc2:
v_mov_b32 v16, 0
v_mov_b32 v17, 0
v_mov_b32 v18, 0
v_mov_b32 v19, 0
s_lshl_b32 s44, s10, 10
v_lshl_add_u32 v234, v0, 4, s44
ds_write_b128 v234, v[16:19]
s_cmp_lg_u32 s3, 0
s_cbranch_scc1 L_notouch
s_bfe_u32 s44, s2, 0x30003
s_mul_i32 s44, s44, (L_codeend-L_pc2+1023)/1024
v_add_u32 v1, s44, v0
v_min_u32 v1, (L_codeend-L_pc2-4)/128, v1
v_lshlrev_b32 v1, 7, v1
global_load_dword v254, v1, s[96:97]
L_notouch:
s_add_u32 s96, s96, L_ones-L_pc2
s_addc_u32 s97, s97, 0
s_waitcnt lgkmcnt(0)

s_barrier
s_branch L_compute
L_lrest:
s_bfe_u32 s4, s2, 0x10002
s_lshl_b32 s8, s4, 3
s_add_u32 s8, s8, s6
s_lshl_b32 s9, s8, 2
s_add_u32 s9, s9, s5
s_lshl_b32 s9, s9, 2
s_add_u32 s9, s9, s7
s_mov_b32 s57, 0
s_mov_b64 s[16:17], s[60:61]
s_mov_b32 s18, 8388608
s_mov_b32 s19, 0x20000
s_mov_b64 s[20:21], s[62:63]
s_mov_b32 s22, 8388608
s_mov_b32 s23, 0x20000
s_mov_b32 s30, 4718592
s_mov_b32 s31, 0x20000
s_mov_b32 s34, 268435456
s_mov_b32 s35, 0x20000
s_mov_b64 s[36:37], s[68:69]
s_mov_b32 s38, 2359296
s_mov_b32 s39, 0x20000
s_mov_b64 s[40:41], s[70:71]
s_mov_b32 s42, 256
s_mov_b32 s43, 0x20000
v_lshl_add_u32 v10, v1, 8, v4
v_add_u32 v10, s98, v10
v_mov_b32 v208, v10
v_xor_b32 v209, 16, v10
v_xor_b32 v210, 32, v10
v_xor_b32 v211, 48, v10
v_mul_u32_u24 v6, 1152, v1
s_xor_b32 s45, s5, 3
s_lshl_b32 s45, s45, 6
v_xor_b32 v7, s45, v4
v_add_u32 v6, v6, v7
s_mul_i32 s44, s10, 18432
v_add_u32 v212, s44, v6
v_add_u32 v213, 3584, v212
v_add_u32 v214, 7168, v212
v_add_u32 v215, 10752, v212
v_lshl_add_u32 v8, v3, 2, v1
v_mul_u32_u24 v6, 1152, v8
s_mul_i32 s44, s10, 36864
v_add_u32 v6, s44, v6
v_and_b32 v7, 0x7f, v7
v_add_u32 v220, v6, v7
v_add_u32 v221, 8192, v220
v_add_u32 v222, 16384, v220
v_add_u32 v223, 24576, v220
v_and_b32 v7, 0x7f, v4
v_add_u32 v216, v6, v7
v_add_u32 v217, 8192, v216
v_add_u32 v218, 16384, v216
v_add_u32 v219, 24576, v216
v_add_u32 v6, s7, v0
v_and_b32 v6, 3, v6
s_andn2_b32 s44, s9, 3
v_add_u32 v6, s44, v6
v_lshlrev_b32 v6, 2, v6
v_add_u32 v6, s10, v6
v_lshlrev_b32 v11, 7, v6
v_lshlrev_b32 v6, 4, v0
v_add_u32 v20, s98, v6
s_lshl_b32 s44, s10, 10
v_add_u32 v12, s44, v6
v_mul_u32_u24 v13, 516, v2
s_lshl_b32 s50, s6, 5
s_add_u32 s50, s50, s11
s_lshl_b32 s50, s50, 15
s_mul_i32 s53, s11, 147456
s_mul_i32 s51, s5, 1179648
s_lshl_b32 s44, s7, 8
s_add_u32 s51, s51, s44
s_mov_b32 s56, 0
s_mov_b32 s94, 1
s_mov_b32 s101, 0
s_bfe_u32 s100, s2, 0x20005
v_mov_b32 v15, 0
v_mov_b32 v16, 0
v_mov_b32 v19, s95
v_mov_b32 v22, 1
v_mov_b32 v23, 1
s_add_u32 s52, s55, 1
s_add_u32 s55, s55, 1
s_cmp_eq_u32 s55, 8
s_cselect_b32 s55, 0, s55
s_lshl_b32 s54, s52, 7
s_add_u32 s54, s54, s48
s_add_u32 m0, s98, 53248
s_add_u32 s99, s54, 0
buffer_load_dwordx4 v200, s[12:15], s99 offen offset:0 lds
buffer_load_dwordx4 v201, s[12:15], s99 offen offset:1024 lds
buffer_load_dwordx4 v202, s[12:15], s99 offen offset:2048 lds
buffer_load_dwordx4 v203, s[12:15], s99 offen offset:3072 lds
s_waitcnt vmcnt(10)
s_lshl_b32 s54, s52, 19
s_add_u32 s54, s54, s49
s_add_u32 m0, s98, 69632
s_add_u32 s99, s54, 0
buffer_load_dwordx4 v204, s[24:27], s99 offen offset:0 lds
buffer_load_dwordx4 v205, s[24:27], s99 offen offset:1024 lds
buffer_load_dwordx4 v206, s[24:27], s99 offen offset:2048 lds
buffer_load_dwordx4 v207, s[24:27], s99 offen offset:3072 lds
s_add_u32 m0, s95, 64
s_mov_b64 exec, 3
global_load_lds_dword v18, s[96:97]
s_mov_b64 exec, -1
s_waitcnt vmcnt(10)
s_lshl_b32 s54, s52, 19
s_add_u32 s54, s54, s49
s_add_u32 m0, s98, 86016
s_add_u32 s99, s54, 262144
buffer_load_dwordx4 v204, s[24:27], s99 offen offset:0 lds
buffer_load_dwordx4 v205, s[24:27], s99 offen offset:1024 lds
buffer_load_dwordx4 v206, s[24:27], s99 offen offset:2048 lds
buffer_load_dwordx4 v207, s[24:27], s99 offen offset:3072 lds
s_add_u32 m0, s95, 96
s_mov_b64 exec, 3
global_load_lds_dword v18, s[96:97]
s_mov_b64 exec, -1
s_waitcnt vmcnt(10)
s_add_u32 s52, s55, 1
s_add_u32 s55, s55, 1
s_cmp_eq_u32 s55, 8
s_cselect_b32 s55, 0, s55
s_lshl_b32 s54, s52, 7
s_add_u32 s54, s54, s48
s_add_u32 m0, s98, 102400
s_add_u32 s99, s54, 0
buffer_load_dwordx4 v200, s[12:15], s99 offen offset:0 lds
buffer_load_dwordx4 v201, s[12:15], s99 offen offset:1024 lds
buffer_load_dwordx4 v202, s[12:15], s99 offen offset:2048 lds
buffer_load_dwordx4 v203, s[12:15], s99 offen offset:3072 lds
s_waitcnt vmcnt(10)
s_lshl_b32 s54, s52, 19
s_add_u32 s54, s54, s49
s_add_u32 m0, s98, 118784
s_add_u32 s99, s54, 0
buffer_load_dwordx4 v204, s[24:27], s99 offen offset:0 lds
buffer_load_dwordx4 v205, s[24:27], s99 offen offset:1024 lds
buffer_load_dwordx4 v206, s[24:27], s99 offen offset:2048 lds
buffer_load_dwordx4 v207, s[24:27], s99 offen offset:3072 lds
s_add_u32 m0, s95, 128
s_mov_b64 exec, 3
global_load_lds_dword v18, s[96:97]
s_mov_b64 exec, -1
s_waitcnt vmcnt(10)
s_lshl_b32 s54, s52, 19
s_add_u32 s54, s54, s49
s_add_u32 m0, s98, 135168
s_add_u32 s99, s54, 262144
buffer_load_dwordx4 v204, s[24:27], s99 offen offset:0 lds
buffer_load_dwordx4 v205, s[24:27], s99 offen offset:1024 lds
buffer_load_dwordx4 v206, s[24:27], s99 offen offset:2048 lds
buffer_load_dwordx4 v207, s[24:27], s99 offen offset:3072 lds
s_add_u32 m0, s95, 160
s_mov_b64 exec, 3
global_load_lds_dword v18, s[96:97]
s_mov_b64 exec, -1
s_waitcnt vmcnt(10)
L_fchk9:
ds_read_b32 v4, v13 offset:2284
s_waitcnt lgkmcnt(0)
v_cmp_ne_u32 vcc, 1, v4
s_nop 1
s_cbranch_vccz L_fok9
s_sleep 1
s_add_u32 s57, s57, 1
s_cmp_gt_u32 s57, 4194304
s_cbranch_scc1 L_fok9
s_branch L_fchk9
L_fok9:
s_add_u32 s52, s55, 1
s_add_u32 s55, s55, 1
s_cmp_eq_u32 s55, 8
s_cselect_b32 s55, 0, s55
s_lshl_b32 s54, s52, 7
s_add_u32 s54, s54, s48
s_add_u32 m0, s98, 4096
s_add_u32 s99, s54, 0
buffer_load_dwordx4 v200, s[12:15], s99 offen offset:0 lds
buffer_load_dwordx4 v201, s[12:15], s99 offen offset:1024 lds
buffer_load_dwordx4 v202, s[12:15], s99 offen offset:2048 lds
buffer_load_dwordx4 v203, s[12:15], s99 offen offset:3072 lds
s_waitcnt vmcnt(10)
s_lshl_b32 s54, s52, 19
s_add_u32 s54, s54, s49
s_add_u32 m0, s98, 20480
s_add_u32 s99, s54, 0
buffer_load_dwordx4 v204, s[24:27], s99 offen offset:0 lds
buffer_load_dwordx4 v205, s[24:27], s99 offen offset:1024 lds
buffer_load_dwordx4 v206, s[24:27], s99 offen offset:2048 lds
buffer_load_dwordx4 v207, s[24:27], s99 offen offset:3072 lds
s_add_u32 m0, s95, 192
s_mov_b64 exec, 3
global_load_lds_dword v18, s[96:97]
s_mov_b64 exec, -1
s_waitcnt vmcnt(10)
L_fchk11:
ds_read_b32 v4, v13 offset:2280
s_waitcnt lgkmcnt(0)
v_cmp_ne_u32 vcc, 1, v4
s_nop 1
s_cbranch_vccz L_fok11
s_sleep 1
s_add_u32 s57, s57, 1
s_cmp_gt_u32 s57, 4194304
s_cbranch_scc1 L_fok11
s_branch L_fchk11
L_fok11:
s_lshl_b32 s54, s52, 19
s_add_u32 s54, s54, s49
s_add_u32 m0, s98, 36864
s_add_u32 s99, s54, 262144
buffer_load_dwordx4 v204, s[24:27], s99 offen offset:0 lds
buffer_load_dwordx4 v205, s[24:27], s99 offen offset:1024 lds
buffer_load_dwordx4 v206, s[24:27], s99 offen offset:2048 lds
buffer_load_dwordx4 v207, s[24:27], s99 offen offset:3072 lds
s_add_u32 m0, s95, 224
s_mov_b64 exec, 3
global_load_lds_dword v18, s[96:97]
s_mov_b64 exec, -1
s_waitcnt vmcnt(10)
L_fchk12:
ds_read_b32 v4, v13 offset:2276
s_waitcnt lgkmcnt(0)
v_cmp_ne_u32 vcc, 1, v4
s_nop 1
s_cbranch_vccz L_fok12
s_sleep 1
s_add_u32 s57, s57, 1
s_cmp_gt_u32 s57, 4194304
s_cbranch_scc1 L_fok12
s_branch L_fchk12
L_fok12:
s_add_u32 s52, s55, 1
s_add_u32 s55, s55, 1
s_cmp_eq_u32 s55, 8
s_cselect_b32 s55, 0, s55
s_lshl_b32 s54, s52, 7
s_add_u32 s54, s54, s48
s_add_u32 m0, s98, 53248
s_add_u32 s99, s54, 0
buffer_load_dwordx4 v200, s[12:15], s99 offen offset:0 lds
buffer_load_dwordx4 v201, s[12:15], s99 offen offset:1024 lds
buffer_load_dwordx4 v202, s[12:15], s99 offen offset:2048 lds
buffer_load_dwordx4 v203, s[12:15], s99 offen offset:3072 lds
s_waitcnt vmcnt(10)
s_lshl_b32 s54, s52, 19
s_add_u32 s54, s54, s49
s_add_u32 m0, s98, 69632
s_add_u32 s99, s54, 0
buffer_load_dwordx4 v204, s[24:27], s99 offen offset:0 lds
buffer_load_dwordx4 v205, s[24:27], s99 offen offset:1024 lds
buffer_load_dwordx4 v206, s[24:27], s99 offen offset:2048 lds
buffer_load_dwordx4 v207, s[24:27], s99 offen offset:3072 lds
s_add_u32 m0, s95, 256
s_mov_b64 exec, 3
global_load_lds_dword v18, s[96:97]
s_mov_b64 exec, -1
s_waitcnt vmcnt(10)
s_cmp_lg_u32 s100, 0
s_cbranch_scc1 L_skip14
v_lshrrev_b32 v1, 1, v0
s_lshl_b32 s44, s10, 5
v_add_u32 v1, s44, v1
v_mul_u32_u24 v1, 1152, v1
v_and_b32 v8, 1, v0
v_lshl_add_u32 v1, v8, 7, v1
s_mul_i32 s44, s6, 147456
s_add_u32 s44, s44, s51
buffer_load_dword v17, v1, s[28:31], s44 offen
v_and_b32 v1, 7, v0
s_lshl_b32 s44, s10, 3
v_add_u32 v1, s44, v1
v_mul_u32_u24 v1, 1152, v1
s_mul_i32 s44, s6, 36864
s_add_u32 s44, s44, s53
s_add_u32 s44, s44, 1024
s_mov_b64 exec, 0xff
buffer_load_dword v17, v1, s[28:31], s44 offen
s_mov_b64 exec, -1
L_skip14:
L_fchk15:
ds_read_b32 v4, v13 offset:2272
s_waitcnt lgkmcnt(0)
v_cmp_ne_u32 vcc, 1, v4
s_nop 1
s_cbranch_vccz L_fok15
s_sleep 1
s_add_u32 s57, s57, 1
s_cmp_gt_u32 s57, 4194304
s_cbranch_scc1 L_fok15
s_branch L_fchk15
L_fok15:
s_lshl_b32 s54, s52, 19
s_add_u32 s54, s54, s49
s_add_u32 m0, s98, 86016
s_add_u32 s99, s54, 262144
buffer_load_dwordx4 v204, s[24:27], s99 offen offset:0 lds
buffer_load_dwordx4 v205, s[24:27], s99 offen offset:1024 lds
buffer_load_dwordx4 v206, s[24:27], s99 offen offset:2048 lds
buffer_load_dwordx4 v207, s[24:27], s99 offen offset:3072 lds
s_add_u32 m0, s95, 288
s_mov_b64 exec, 3
global_load_lds_dword v18, s[96:97]
s_mov_b64 exec, -1
s_waitcnt vmcnt(10)
s_cmp_lg_u32 s100, 1
s_cbranch_scc1 L_skip16
v_lshrrev_b32 v1, 1, v0
s_lshl_b32 s44, s10, 5
v_add_u32 v1, s44, v1
v_mul_u32_u24 v1, 1152, v1
v_and_b32 v8, 1, v0
v_lshl_add_u32 v1, v8, 7, v1
s_mul_i32 s44, s6, 147456
s_add_u32 s44, s44, s51
buffer_load_dword v17, v1, s[28:31], s44 offen
v_and_b32 v1, 7, v0
s_lshl_b32 s44, s10, 3
v_add_u32 v1, s44, v1
v_mul_u32_u24 v1, 1152, v1
s_mul_i32 s44, s6, 36864
s_add_u32 s44, s44, s53
s_add_u32 s44, s44, 1024
s_mov_b64 exec, 0xff
buffer_load_dword v17, v1, s[28:31], s44 offen
s_mov_b64 exec, -1
L_skip16:
L_fchk17:
ds_read_b32 v4, v13 offset:2268
s_waitcnt lgkmcnt(0)
v_cmp_ne_u32 vcc, 1, v4
s_nop 1
s_cbranch_vccz L_fok17
s_sleep 1
s_add_u32 s57, s57, 1
s_cmp_gt_u32 s57, 4194304
s_cbranch_scc1 L_fok17
s_branch L_fchk17
L_fok17:
s_add_u32 s52, s55, 1
s_add_u32 s55, s55, 1
s_cmp_eq_u32 s55, 8
s_cselect_b32 s55, 0, s55
s_lshl_b32 s54, s52, 7
s_add_u32 s54, s54, s48
s_add_u32 m0, s98, 102400
s_add_u32 s99, s54, 0
buffer_load_dwordx4 v200, s[12:15], s99 offen offset:0 lds
buffer_load_dwordx4 v201, s[12:15], s99 offen offset:1024 lds
buffer_load_dwordx4 v202, s[12:15], s99 offen offset:2048 lds
buffer_load_dwordx4 v203, s[12:15], s99 offen offset:3072 lds
s_add_u32 m0, s95, 324
s_mov_b64 exec, 1
global_load_lds_dword v18, s[96:97]
s_mov_b64 exec, -1
s_waitcnt vmcnt(10)
s_cmp_lg_u32 s100, 2
s_cbranch_scc1 L_skip18
v_lshrrev_b32 v1, 1, v0
s_lshl_b32 s44, s10, 5
v_add_u32 v1, s44, v1
v_mul_u32_u24 v1, 1152, v1
v_and_b32 v8, 1, v0
v_lshl_add_u32 v1, v8, 7, v1
s_mul_i32 s44, s6, 147456
s_add_u32 s44, s44, s51
buffer_load_dword v17, v1, s[28:31], s44 offen
v_and_b32 v1, 7, v0
s_lshl_b32 s44, s10, 3
v_add_u32 v1, s44, v1
v_mul_u32_u24 v1, 1152, v1
s_mul_i32 s44, s6, 36864
s_add_u32 s44, s44, s53
s_add_u32 s44, s44, 1024
s_mov_b64 exec, 0xff
buffer_load_dword v17, v1, s[28:31], s44 offen
s_mov_b64 exec, -1
L_skip18:
s_lshl_b32 s54, s52, 19
s_add_u32 s54, s54, s49
s_add_u32 m0, s98, 118784
s_add_u32 s99, s54, 0
buffer_load_dwordx4 v204, s[24:27], s99 offen offset:0 lds
buffer_load_dwordx4 v205, s[24:27], s99 offen offset:1024 lds
buffer_load_dwordx4 v206, s[24:27], s99 offen offset:2048 lds
buffer_load_dwordx4 v207, s[24:27], s99 offen offset:3072 lds
s_add_u32 m0, s95, 320
s_mov_b64 exec, 1
global_load_lds_dword v18, s[96:97]
s_mov_b64 exec, -1
s_waitcnt vmcnt(10)
s_cmp_lg_u32 s100, 3
s_cbranch_scc1 L_skip20
v_lshrrev_b32 v1, 1, v0
s_lshl_b32 s44, s10, 5
v_add_u32 v1, s44, v1
v_mul_u32_u24 v1, 1152, v1
v_and_b32 v8, 1, v0
v_lshl_add_u32 v1, v8, 7, v1
s_mul_i32 s44, s6, 147456
s_add_u32 s44, s44, s51
buffer_load_dword v17, v1, s[28:31], s44 offen
v_and_b32 v1, 7, v0
s_lshl_b32 s44, s10, 3
v_add_u32 v1, s44, v1
v_mul_u32_u24 v1, 1152, v1
s_mul_i32 s44, s6, 36864
s_add_u32 s44, s44, s53
s_add_u32 s44, s44, 1024
s_mov_b64 exec, 0xff
buffer_load_dword v17, v1, s[28:31], s44 offen
s_mov_b64 exec, -1
L_skip20:
L_fchk21:
ds_read_b32 v4, v13 offset:2264
s_waitcnt lgkmcnt(0)
v_cmp_ne_u32 vcc, 1, v4
s_nop 1
s_cbranch_vccz L_fok21
s_sleep 1
s_add_u32 s57, s57, 1
s_cmp_gt_u32 s57, 4194304
s_cbranch_scc1 L_fok21
s_branch L_fchk21
L_fok21:
s_lshl_b32 s54, s52, 19
s_add_u32 s54, s54, s49
s_add_u32 m0, s98, 135168
s_add_u32 s99, s54, 262144
buffer_load_dwordx4 v204, s[24:27], s99 offen offset:0 lds
buffer_load_dwordx4 v205, s[24:27], s99 offen offset:1024 lds
buffer_load_dwordx4 v206, s[24:27], s99 offen offset:2048 lds
buffer_load_dwordx4 v207, s[24:27], s99 offen offset:3072 lds
s_add_u32 m0, s95, 352
s_mov_b64 exec, 3
global_load_lds_dword v18, s[96:97]
s_mov_b64 exec, -1
s_waitcnt vmcnt(10)
L_fchk22:
ds_read_b32 v4, v13 offset:2260
s_waitcnt lgkmcnt(0)
v_cmp_ne_u32 vcc, 1, v4
s_nop 1
s_cbranch_vccz L_fok22
s_sleep 1
s_add_u32 s57, s57, 1
s_cmp_gt_u32 s57, 4194304
s_cbranch_scc1 L_fok22
s_branch L_fchk22
L_fok22:
s_add_u32 s52, s55, 1
s_add_u32 s55, s55, 1
s_cmp_eq_u32 s55, 8
s_cselect_b32 s55, 0, s55
s_lshl_b32 s54, s52, 7
s_add_u32 s54, s54, s48
s_add_u32 m0, s98, 4096
s_add_u32 s99, s54, 0
buffer_load_dwordx4 v200, s[12:15], s99 offen offset:0 lds
buffer_load_dwordx4 v201, s[12:15], s99 offen offset:1024 lds
buffer_load_dwordx4 v202, s[12:15], s99 offen offset:2048 lds
buffer_load_dwordx4 v203, s[12:15], s99 offen offset:3072 lds
s_waitcnt vmcnt(10)
s_lshl_b32 s54, s52, 19
s_add_u32 s54, s54, s49
s_add_u32 m0, s98, 20480
s_add_u32 s99, s54, 0
buffer_load_dwordx4 v204, s[24:27], s99 offen offset:0 lds
buffer_load_dwordx4 v205, s[24:27], s99 offen offset:1024 lds
buffer_load_dwordx4 v206, s[24:27], s99 offen offset:2048 lds
buffer_load_dwordx4 v207, s[24:27], s99 offen offset:3072 lds
s_add_u32 m0, s95, 384
s_mov_b64 exec, 3
global_load_lds_dword v18, s[96:97]
s_mov_b64 exec, -1
s_waitcnt vmcnt(10)
s_cmp_lg_u32 s100, 0
s_cbranch_scc1 L_skip24
L_fchk24:
ds_read_b32 v4, v13 offset:2256
s_waitcnt lgkmcnt(0)
v_cmp_ne_u32 vcc, 1, v4
s_nop 1
s_cbranch_vccz L_fok24
s_sleep 1
s_add_u32 s57, s57, 1
s_cmp_gt_u32 s57, 4194304
s_cbranch_scc1 L_fok24
s_branch L_fchk24
L_fok24:
s_add_u32 m0, s98, 36864
s_add_u32 s99, s50, 0
buffer_load_dwordx4 v208, s[16:19], s99 offen offset:0 nt lds
buffer_load_dwordx4 v209, s[16:19], s99 offen offset:1024 nt lds
buffer_load_dwordx4 v210, s[16:19], s99 offen offset:2048 nt lds
buffer_load_dwordx4 v211, s[16:19], s99 offen offset:3072 nt lds
s_add_u32 m0, s95, 576
s_mov_b64 exec, 3
global_load_lds_dword v18, s[96:97]
s_mov_b64 exec, -1
s_waitcnt vmcnt(10)
L_skip24:
s_cmp_lg_u32 s100, 0
s_cbranch_scc1 L_skip25
L_fchk25:
ds_read_b32 v4, v13 offset:2252
s_waitcnt lgkmcnt(0)
v_cmp_ne_u32 vcc, 1, v4
s_nop 1
s_cbranch_vccz L_fok25
s_sleep 1
s_add_u32 s57, s57, 1
s_cmp_gt_u32 s57, 4194304
s_cbranch_scc1 L_fok25
s_branch L_fchk25
L_fok25:
s_add_u32 m0, s98, 53248
s_add_u32 s99, s50, 16384
buffer_load_dwordx4 v208, s[16:19], s99 offen offset:0 nt lds
buffer_load_dwordx4 v209, s[16:19], s99 offen offset:1024 nt lds
buffer_load_dwordx4 v210, s[16:19], s99 offen offset:2048 nt lds
buffer_load_dwordx4 v211, s[16:19], s99 offen offset:3072 nt lds
s_add_u32 m0, s95, 608
s_mov_b64 exec, 3
global_load_lds_dword v18, s[96:97]
s_mov_b64 exec, -1
s_waitcnt vmcnt(10)
L_skip25:
L_fchk26:
ds_read_b32 v4, v13 offset:2252
s_waitcnt lgkmcnt(0)
v_cmp_ne_u32 vcc, 1, v4
s_nop 1
s_cbranch_vccz L_fok26
s_sleep 1
s_add_u32 s57, s57, 1
s_cmp_gt_u32 s57, 4194304
s_cbranch_scc1 L_fok26
s_branch L_fchk26
L_fok26:
s_lshl_b32 s54, s52, 19
s_add_u32 s54, s54, s49
s_add_u32 m0, s98, 69632
s_add_u32 s99, s54, 262144
buffer_load_dwordx4 v204, s[24:27], s99 offen offset:0 lds
buffer_load_dwordx4 v205, s[24:27], s99 offen offset:1024 lds
buffer_load_dwordx4 v206, s[24:27], s99 offen offset:2048 lds
buffer_load_dwordx4 v207, s[24:27], s99 offen offset:3072 lds
s_add_u32 m0, s95, 416
s_mov_b64 exec, 3
global_load_lds_dword v18, s[96:97]
s_mov_b64 exec, -1
s_waitcnt vmcnt(10)
s_cmp_lg_u32 s100, 1
s_cbranch_scc1 L_skip27
s_add_u32 m0, s98, 36864
s_add_u32 s99, s50, 0
buffer_load_dwordx4 v208, s[16:19], s99 offen offset:0 nt lds
buffer_load_dwordx4 v209, s[16:19], s99 offen offset:1024 nt lds
buffer_load_dwordx4 v210, s[16:19], s99 offen offset:2048 nt lds
buffer_load_dwordx4 v211, s[16:19], s99 offen offset:3072 nt lds
s_add_u32 m0, s95, 576
s_mov_b64 exec, 3
global_load_lds_dword v18, s[96:97]
s_mov_b64 exec, -1
s_waitcnt vmcnt(10)
L_skip27:
s_cmp_lg_u32 s100, 1
s_cbranch_scc1 L_skip28
s_add_u32 m0, s98, 53248
s_add_u32 s99, s50, 16384
buffer_load_dwordx4 v208, s[16:19], s99 offen offset:0 nt lds
buffer_load_dwordx4 v209, s[16:19], s99 offen offset:1024 nt lds
buffer_load_dwordx4 v210, s[16:19], s99 offen offset:2048 nt lds
buffer_load_dwordx4 v211, s[16:19], s99 offen offset:3072 nt lds
s_add_u32 m0, s95, 608
s_mov_b64 exec, 3
global_load_lds_dword v18, s[96:97]
s_mov_b64 exec, -1
s_waitcnt vmcnt(10)
L_skip28:
L_fchk29:
ds_read_b32 v4, v13 offset:2248
s_waitcnt lgkmcnt(0)
v_cmp_ne_u32 vcc, 1, v4
s_nop 1
s_cbranch_vccz L_fok29
s_sleep 1
s_add_u32 s57, s57, 1
s_cmp_gt_u32 s57, 4194304
s_cbranch_scc1 L_fok29
s_branch L_fchk29
L_fok29:
s_add_u32 s52, s55, 1
s_add_u32 s55, s55, 1
s_cmp_eq_u32 s55, 8
s_cselect_b32 s55, 0, s55
s_lshl_b32 s54, s52, 7
s_add_u32 s54, s54, s48
s_add_u32 m0, s98, 86016
s_add_u32 s99, s54, 0
buffer_load_dwordx4 v200, s[12:15], s99 offen offset:0 lds
buffer_load_dwordx4 v201, s[12:15], s99 offen offset:1024 lds
buffer_load_dwordx4 v202, s[12:15], s99 offen offset:2048 lds
buffer_load_dwordx4 v203, s[12:15], s99 offen offset:3072 lds
s_add_u32 m0, s95, 452
s_mov_b64 exec, 1
global_load_lds_dword v18, s[96:97]
s_mov_b64 exec, -1
s_waitcnt vmcnt(10)
s_cmp_lg_u32 s100, 2
s_cbranch_scc1 L_skip30
s_add_u32 m0, s98, 36864
s_add_u32 s99, s50, 0
buffer_load_dwordx4 v208, s[16:19], s99 offen offset:0 nt lds
buffer_load_dwordx4 v209, s[16:19], s99 offen offset:1024 nt lds
buffer_load_dwordx4 v210, s[16:19], s99 offen offset:2048 nt lds
buffer_load_dwordx4 v211, s[16:19], s99 offen offset:3072 nt lds
s_add_u32 m0, s95, 576
s_mov_b64 exec, 3
global_load_lds_dword v18, s[96:97]
s_mov_b64 exec, -1
s_waitcnt vmcnt(10)
L_skip30:
s_cmp_lg_u32 s100, 2
s_cbranch_scc1 L_skip31
s_add_u32 m0, s98, 53248
s_add_u32 s99, s50, 16384
buffer_load_dwordx4 v208, s[16:19], s99 offen offset:0 nt lds
buffer_load_dwordx4 v209, s[16:19], s99 offen offset:1024 nt lds
buffer_load_dwordx4 v210, s[16:19], s99 offen offset:2048 nt lds
buffer_load_dwordx4 v211, s[16:19], s99 offen offset:3072 nt lds
s_add_u32 m0, s95, 608
s_mov_b64 exec, 3
global_load_lds_dword v18, s[96:97]
s_mov_b64 exec, -1
s_waitcnt vmcnt(10)
L_skip31:
L_fchk32:
ds_read_b32 v4, v13 offset:2244
s_waitcnt lgkmcnt(0)
v_cmp_ne_u32 vcc, 1, v4
s_nop 1
s_cbranch_vccz L_fok32
s_sleep 1
s_add_u32 s57, s57, 1
s_cmp_gt_u32 s57, 4194304
s_cbranch_scc1 L_fok32
s_branch L_fchk32
L_fok32:
s_lshl_b32 s54, s52, 19
s_add_u32 s54, s54, s49
s_add_u32 m0, s98, 102400
s_add_u32 s99, s54, 0
buffer_load_dwordx4 v204, s[24:27], s99 offen offset:0 lds
buffer_load_dwordx4 v205, s[24:27], s99 offen offset:1024 lds
buffer_load_dwordx4 v206, s[24:27], s99 offen offset:2048 lds
buffer_load_dwordx4 v207, s[24:27], s99 offen offset:3072 lds
s_add_u32 m0, s95, 448
s_mov_b64 exec, 1
global_load_lds_dword v18, s[96:97]
s_mov_b64 exec, -1
s_waitcnt vmcnt(10)
s_cmp_lg_u32 s100, 3
s_cbranch_scc1 L_skip33
s_add_u32 m0, s98, 36864
s_add_u32 s99, s50, 0
buffer_load_dwordx4 v208, s[16:19], s99 offen offset:0 nt lds
buffer_load_dwordx4 v209, s[16:19], s99 offen offset:1024 nt lds
buffer_load_dwordx4 v210, s[16:19], s99 offen offset:2048 nt lds
buffer_load_dwordx4 v211, s[16:19], s99 offen offset:3072 nt lds
s_add_u32 m0, s95, 576
s_mov_b64 exec, 3
global_load_lds_dword v18, s[96:97]
s_mov_b64 exec, -1
s_waitcnt vmcnt(10)
L_skip33:
s_cmp_lg_u32 s100, 3
s_cbranch_scc1 L_skip34
s_add_u32 m0, s98, 53248
s_add_u32 s99, s50, 16384
buffer_load_dwordx4 v208, s[16:19], s99 offen offset:0 nt lds
buffer_load_dwordx4 v209, s[16:19], s99 offen offset:1024 nt lds
buffer_load_dwordx4 v210, s[16:19], s99 offen offset:2048 nt lds
buffer_load_dwordx4 v211, s[16:19], s99 offen offset:3072 nt lds
s_add_u32 m0, s95, 608
s_mov_b64 exec, 3
global_load_lds_dword v18, s[96:97]
s_mov_b64 exec, -1
s_waitcnt vmcnt(10)
L_skip34:
s_lshl_b32 s54, s52, 19
s_add_u32 s54, s54, s49
s_add_u32 m0, s98, 118784
s_add_u32 s99, s54, 262144
buffer_load_dwordx4 v204, s[24:27], s99 offen offset:0 lds
buffer_load_dwordx4 v205, s[24:27], s99 offen offset:1024 lds
buffer_load_dwordx4 v206, s[24:27], s99 offen offset:2048 lds
buffer_load_dwordx4 v207, s[24:27], s99 offen offset:3072 lds
s_add_u32 m0, s95, 480
s_mov_b64 exec, 3
global_load_lds_dword v18, s[96:97]
s_mov_b64 exec, -1
s_waitcnt vmcnt(10)
L_fchk36:
ds_read_b32 v4, v13 offset:2240
s_waitcnt lgkmcnt(0)
v_cmp_ne_u32 vcc, 1, v4
s_nop 1
s_cbranch_vccz L_fok36
s_sleep 1
s_add_u32 s57, s57, 1
s_cmp_gt_u32 s57, 4194304
s_cbranch_scc1 L_fok36
s_branch L_fchk36
L_fok36:
s_add_u32 s52, s55, 1
s_add_u32 s55, s55, 1
s_cmp_eq_u32 s55, 8
s_cselect_b32 s55, 0, s55
s_lshl_b32 s54, s52, 7
s_add_u32 s54, s54, s48
s_add_u32 m0, s98, 135168
s_add_u32 s99, s54, 0
buffer_load_dwordx4 v200, s[12:15], s99 offen offset:0 lds
buffer_load_dwordx4 v201, s[12:15], s99 offen offset:1024 lds
buffer_load_dwordx4 v202, s[12:15], s99 offen offset:2048 lds
buffer_load_dwordx4 v203, s[12:15], s99 offen offset:3072 lds
s_waitcnt vmcnt(10)
L_fchk37:
ds_read_b32 v4, v13 offset:2236
s_waitcnt lgkmcnt(0)
v_cmp_ne_u32 vcc, 1, v4
s_nop 1
s_cbranch_vccz L_fok37
s_sleep 1
s_add_u32 s57, s57, 1
s_cmp_gt_u32 s57, 4194304
s_cbranch_scc1 L_fok37
s_branch L_fchk37
L_fok37:
s_lshl_b32 s54, s52, 19
s_add_u32 s54, s54, s49
s_add_u32 m0, s98, 4096
s_add_u32 s99, s54, 0
buffer_load_dwordx4 v204, s[24:27], s99 offen offset:0 lds
buffer_load_dwordx4 v205, s[24:27], s99 offen offset:1024 lds
buffer_load_dwordx4 v206, s[24:27], s99 offen offset:2048 lds
buffer_load_dwordx4 v207, s[24:27], s99 offen offset:3072 lds
s_add_u32 m0, s95, 512
s_mov_b64 exec, 3
global_load_lds_dword v18, s[96:97]
s_mov_b64 exec, -1
s_waitcnt vmcnt(10)
s_lshl_b32 s54, s52, 19
s_add_u32 s54, s54, s49
s_add_u32 m0, s98, 20480
s_add_u32 s99, s54, 262144
buffer_load_dwordx4 v204, s[24:27], s99 offen offset:0 lds
buffer_load_dwordx4 v205, s[24:27], s99 offen offset:1024 lds
buffer_load_dwordx4 v206, s[24:27], s99 offen offset:2048 lds
buffer_load_dwordx4 v207, s[24:27], s99 offen offset:3072 lds
s_add_u32 m0, s95, 544
s_mov_b64 exec, 3
global_load_lds_dword v18, s[96:97]
s_mov_b64 exec, -1
s_waitcnt vmcnt(10)
L_fchk39:
ds_read_b32 v4, v13 offset:2232
s_waitcnt lgkmcnt(0)
v_cmp_ne_u32 vcc, 1, v4
s_nop 1
s_cbranch_vccz L_fok39
s_sleep 1
s_add_u32 s57, s57, 1
s_cmp_gt_u32 s57, 4194304
s_cbranch_scc1 L_fok39
s_branch L_fchk39
L_fok39:
s_add_u32 m0, s98, 69632
s_add_u32 s99, s50, 32768
buffer_load_dwordx4 v208, s[16:19], s99 offen offset:0 nt lds
buffer_load_dwordx4 v209, s[16:19], s99 offen offset:1024 nt lds
buffer_load_dwordx4 v210, s[16:19], s99 offen offset:2048 nt lds
buffer_load_dwordx4 v211, s[16:19], s99 offen offset:3072 nt lds
s_add_u32 m0, s95, 640
s_mov_b64 exec, 3
global_load_lds_dword v18, s[96:97]
s_mov_b64 exec, -1
s_waitcnt vmcnt(10)
L_fchk40:
ds_read_b32 v4, v13 offset:2228
s_waitcnt lgkmcnt(0)
v_cmp_ne_u32 vcc, 1, v4
s_nop 1
s_cbranch_vccz L_fok40
s_sleep 1
s_add_u32 s57, s57, 1
s_cmp_gt_u32 s57, 4194304
s_cbranch_scc1 L_fok40
s_branch L_fchk40
L_fok40:
s_add_u32 m0, s98, 86016
s_add_u32 s99, s50, 49152
buffer_load_dwordx4 v208, s[16:19], s99 offen offset:0 nt lds
buffer_load_dwordx4 v209, s[16:19], s99 offen offset:1024 nt lds
buffer_load_dwordx4 v210, s[16:19], s99 offen offset:2048 nt lds
buffer_load_dwordx4 v211, s[16:19], s99 offen offset:3072 nt lds
s_add_u32 m0, s95, 672
s_mov_b64 exec, 3
global_load_lds_dword v18, s[96:97]
s_mov_b64 exec, -1
s_waitcnt vmcnt(10)
s_add_u32 m0, s98, 102400
s_add_u32 s99, s50, 0
buffer_load_dwordx4 v10, s[20:23], s99 offen offset:0 nt lds
buffer_load_dwordx4 v10, s[20:23], s99 offen offset:1024 nt lds
buffer_load_dwordx4 v10, s[20:23], s99 offen offset:2048 nt lds
buffer_load_dwordx4 v10, s[20:23], s99 offen offset:3072 nt lds
s_add_u32 m0, s95, 704
s_mov_b64 exec, 3
global_load_lds_dword v18, s[96:97]
s_mov_b64 exec, -1
s_waitcnt vmcnt(10)
L_fchk42:
ds_read_b32 v4, v13 offset:2224
s_waitcnt lgkmcnt(0)
v_cmp_ne_u32 vcc, 1, v4
s_nop 1
s_cbranch_vccz L_fok42
s_sleep 1
s_add_u32 s57, s57, 1
s_cmp_gt_u32 s57, 4194304
s_cbranch_scc1 L_fok42
s_branch L_fchk42
L_fok42:
s_add_u32 m0, s98, 118784
s_add_u32 s99, s50, 16384
buffer_load_dwordx4 v10, s[20:23], s99 offen offset:0 nt lds
buffer_load_dwordx4 v10, s[20:23], s99 offen offset:1024 nt lds
buffer_load_dwordx4 v10, s[20:23], s99 offen offset:2048 nt lds
buffer_load_dwordx4 v10, s[20:23], s99 offen offset:3072 nt lds
s_add_u32 m0, s95, 736
s_mov_b64 exec, 3
global_load_lds_dword v18, s[96:97]
s_mov_b64 exec, -1
s_waitcnt vmcnt(10)
s_lshl_b32 s44, s8, 2
buffer_load_dword v14, v18, s[40:43], s44 offen sc1
L_fchk44:
ds_read_b32 v4, v13 offset:2220
s_waitcnt lgkmcnt(0)
v_cmp_ne_u32 vcc, 1, v4
s_nop 1
s_cbranch_vccz L_fok44
s_sleep 1
s_add_u32 s57, s57, 1
s_cmp_gt_u32 s57, 4194304
s_cbranch_scc1 L_fok44
s_branch L_fchk44
L_fok44:
s_add_u32 s54, s7, 0
s_and_b32 s54, s54, 3
s_mul_i32 s54, s54, 294912
s_add_u32 s54, s54, s51
s_add_u32 m0, s98, 4096
s_add_u32 s99, s54, 0
buffer_load_dwordx4 v212, s[28:31], s99 offen offset:0 lds
buffer_load_dwordx4 v213, s[28:31], s99 offen offset:1024 lds
buffer_load_dwordx4 v214, s[28:31], s99 offen offset:2048 lds
buffer_load_dwordx4 v215, s[28:31], s99 offen offset:3072 lds
s_add_u32 m0, s95, 768
s_mov_b64 exec, 3
global_load_lds_dword v18, s[96:97]
s_mov_b64 exec, -1
s_waitcnt vmcnt(10)
s_add_u32 s54, s7, 0
s_and_b32 s54, s54, 3
s_mul_i32 s54, s54, 294912
s_add_u32 s54, s54, s51
s_add_u32 m0, s98, 135168
s_add_u32 s99, s54, 73728
buffer_load_dwordx4 v212, s[28:31], s99 offen offset:0 lds
buffer_load_dwordx4 v213, s[28:31], s99 offen offset:1024 lds
buffer_load_dwordx4 v214, s[28:31], s99 offen offset:2048 lds
buffer_load_dwordx4 v215, s[28:31], s99 offen offset:3072 lds
s_add_u32 m0, s95, 800
s_mov_b64 exec, 3
global_load_lds_dword v18, s[96:97]
s_mov_b64 exec, -1
s_waitcnt vmcnt(10)
L_fchk46:
ds_read_b32 v4, v13 offset:2216
s_waitcnt lgkmcnt(0)
v_cmp_ne_u32 vcc, 1, v4
s_nop 1
s_cbranch_vccz L_fok46
s_sleep 1
s_add_u32 s57, s57, 1
s_cmp_gt_u32 s57, 4194304
s_cbranch_scc1 L_fok46
s_branch L_fchk46
L_fok46:
s_add_u32 m0, s98, 20480
s_add_u32 s99, s50, 32768
buffer_load_dwordx4 v10, s[20:23], s99 offen offset:0 nt lds
buffer_load_dwordx4 v10, s[20:23], s99 offen offset:1024 nt lds
buffer_load_dwordx4 v10, s[20:23], s99 offen offset:2048 nt lds
buffer_load_dwordx4 v10, s[20:23], s99 offen offset:3072 nt lds
s_add_u32 m0, s95, 832
s_mov_b64 exec, 3
global_load_lds_dword v18, s[96:97]
s_mov_b64 exec, -1
s_waitcnt vmcnt(10)
L_fchk47:
ds_read_b32 v4, v13 offset:2212
s_waitcnt lgkmcnt(0)
v_cmp_ne_u32 vcc, 1, v4
s_nop 1
s_cbranch_vccz L_fok47
s_sleep 1
s_add_u32 s57, s57, 1
s_cmp_gt_u32 s57, 4194304
s_cbranch_scc1 L_fok47
s_branch L_fchk47
L_fok47:
s_add_u32 m0, s98, 36864
s_add_u32 s99, s50, 49152
buffer_load_dwordx4 v10, s[20:23], s99 offen offset:0 nt lds
buffer_load_dwordx4 v10, s[20:23], s99 offen offset:1024 nt lds
buffer_load_dwordx4 v10, s[20:23], s99 offen offset:2048 nt lds
buffer_load_dwordx4 v10, s[20:23], s99 offen offset:3072 nt lds
s_add_u32 m0, s95, 864
s_mov_b64 exec, 3
global_load_lds_dword v18, s[96:97]
s_mov_b64 exec, -1
s_waitcnt vmcnt(10)
L_fchk48:
ds_read_b32 v4, v13 offset:2208
s_waitcnt lgkmcnt(0)
v_cmp_ne_u32 vcc, 1, v4
s_nop 1
s_cbranch_vccz L_fok48
s_sleep 1
s_add_u32 s57, s57, 1
s_cmp_gt_u32 s57, 4194304
s_cbranch_scc1 L_fok48
s_branch L_fchk48
L_fok48:
s_add_u32 m0, s98, 53248
s_add_u32 s99, s53, 1024
buffer_load_dwordx4 v216, s[28:31], s99 offen offset:0 lds
buffer_load_dwordx4 v217, s[28:31], s99 offen offset:1024 lds
buffer_load_dwordx4 v218, s[28:31], s99 offen offset:2048 lds
buffer_load_dwordx4 v219, s[28:31], s99 offen offset:3072 lds
s_add_u32 m0, s95, 896
s_mov_b64 exec, 3
global_load_lds_dword v18, s[96:97]
s_mov_b64 exec, -1
s_waitcnt vmcnt(10)
L_fchk49:
ds_read_b32 v4, v13 offset:2204
s_waitcnt lgkmcnt(0)
v_cmp_ne_u32 vcc, 1, v4
s_nop 1
s_cbranch_vccz L_fok49
s_sleep 1
s_add_u32 s57, s57, 1
s_cmp_gt_u32 s57, 4194304
s_cbranch_scc1 L_fok49
s_branch L_fchk49
L_fok49:
s_add_u32 s54, s7, 0
s_and_b32 s54, s54, 3
s_mul_i32 s54, s54, 294912
s_add_u32 s54, s54, s51
s_add_u32 m0, s98, 69632
s_add_u32 s99, s54, 147456
buffer_load_dwordx4 v212, s[28:31], s99 offen offset:0 lds
buffer_load_dwordx4 v213, s[28:31], s99 offen offset:1024 lds
buffer_load_dwordx4 v214, s[28:31], s99 offen offset:2048 lds
buffer_load_dwordx4 v215, s[28:31], s99 offen offset:3072 lds
s_add_u32 m0, s95, 928
s_mov_b64 exec, 3
global_load_lds_dword v18, s[96:97]
s_mov_b64 exec, -1
s_waitcnt vmcnt(10)
L_fchk50:
ds_read_b32 v4, v13 offset:2200
s_waitcnt lgkmcnt(0)
v_cmp_ne_u32 vcc, 1, v4
s_nop 1
s_cbranch_vccz L_fok50
s_sleep 1
s_add_u32 s57, s57, 1
s_cmp_gt_u32 s57, 4194304
s_cbranch_scc1 L_fok50
s_branch L_fchk50
L_fok50:
s_add_u32 s54, s7, 0
s_and_b32 s54, s54, 3
s_mul_i32 s54, s54, 294912
s_add_u32 s54, s54, s51
s_add_u32 m0, s98, 86016
s_add_u32 s99, s54, 221184
buffer_load_dwordx4 v212, s[28:31], s99 offen offset:0 lds
buffer_load_dwordx4 v213, s[28:31], s99 offen offset:1024 lds
buffer_load_dwordx4 v214, s[28:31], s99 offen offset:2048 lds
buffer_load_dwordx4 v215, s[28:31], s99 offen offset:3072 lds
s_add_u32 m0, s95, 960
s_mov_b64 exec, 3
global_load_lds_dword v18, s[96:97]
s_mov_b64 exec, -1
s_waitcnt vmcnt(10)
L_fchk51:
ds_read_b32 v4, v13 offset:2196
s_waitcnt lgkmcnt(0)
v_cmp_ne_u32 vcc, 1, v4
s_nop 1
s_cbranch_vccz L_fok51
s_sleep 1
s_add_u32 s57, s57, 1
s_cmp_gt_u32 s57, 4194304
s_cbranch_scc1 L_fok51
s_branch L_fchk51
L_fok51:
s_add_u32 m0, s98, 102400
s_add_u32 s99, s53, 148480
buffer_load_dwordx4 v216, s[28:31], s99 offen offset:0 lds
buffer_load_dwordx4 v217, s[28:31], s99 offen offset:1024 lds
buffer_load_dwordx4 v218, s[28:31], s99 offen offset:2048 lds
buffer_load_dwordx4 v219, s[28:31], s99 offen offset:3072 lds
s_add_u32 m0, s95, 992
s_mov_b64 exec, 3
global_load_lds_dword v18, s[96:97]
s_mov_b64 exec, -1
s_waitcnt vmcnt(10)
L_fchk52:
ds_read_b32 v4, v13 offset:2192
s_waitcnt lgkmcnt(0)
v_cmp_ne_u32 vcc, 1, v4
s_nop 1
s_cbranch_vccz L_fok52
s_sleep 1
s_add_u32 s57, s57, 1
s_cmp_gt_u32 s57, 4194304
s_cbranch_scc1 L_fok52
s_branch L_fchk52
L_fok52:
s_add_u32 s54, s7, 1
s_and_b32 s54, s54, 3
s_mul_i32 s54, s54, 294912
s_add_u32 s54, s54, s51
s_add_u32 m0, s98, 118784
s_add_u32 s99, s54, 0
buffer_load_dwordx4 v212, s[28:31], s99 offen offset:0 lds
buffer_load_dwordx4 v213, s[28:31], s99 offen offset:1024 lds
buffer_load_dwordx4 v214, s[28:31], s99 offen offset:2048 lds
buffer_load_dwordx4 v215, s[28:31], s99 offen offset:3072 lds
s_add_u32 m0, s95, 1028
s_mov_b64 exec, 1
global_load_lds_dword v18, s[96:97]
s_mov_b64 exec, -1
s_waitcnt vmcnt(10)
s_lshl_b32 s44, s9, 15
s_add_u32 s99, s44, 20971520
buffer_load_dwordx4 v[32:35], v12, s[32:35], s99 offen sc1 nt
s_add_u32 s99, s44, 20975616
buffer_load_dwordx4 v[36:39], v12, s[32:35], s99 offen sc1 nt
s_add_u32 s99, s44, 20979712
buffer_load_dwordx4 v[40:43], v12, s[32:35], s99 offen sc1 nt
s_add_u32 s99, s44, 20983808
buffer_load_dwordx4 v[44:47], v12, s[32:35], s99 offen sc1 nt
s_lshl_b32 s44, s9, 15
s_add_u32 s99, s44, 20987904
buffer_load_dwordx4 v[48:51], v12, s[32:35], s99 offen sc1 nt
s_add_u32 s99, s44, 20992000
buffer_load_dwordx4 v[52:55], v12, s[32:35], s99 offen sc1 nt
L_fchk55:
ds_read_b32 v4, v13 offset:2188
s_waitcnt lgkmcnt(0)
v_cmp_ne_u32 vcc, 1, v4
s_nop 1
s_cbranch_vccz L_fok55
s_sleep 1
s_add_u32 s57, s57, 1
s_cmp_gt_u32 s57, 4194304
s_cbranch_scc1 L_fok55
s_branch L_fchk55
L_fok55:
s_waitcnt vmcnt(51)
v_readfirstlane_b32 s56, v14
s_nop 1
s_cmp_lg_u32 s56, 0
s_cbranch_scc1 L_ltagok
s_call_b64 s[92:93], L_waittag
L_ltagok:
L_rw55:
s_cmp_gt_u32 s94, 1
s_cbranch_scc1 L_rok55
s_call_b64 s[92:93], L_pollstep
s_add_u32 s57, s57, 1
s_cmp_gt_u32 s57, 4194304
s_cbranch_scc1 L_rok55
s_branch L_rw55
L_rok55:
s_add_u32 s54, s7, 1
s_and_b32 s54, s54, 3
s_andn2_b32 s44, s9, 3
s_add_u32 s54, s54, s44
s_mul_i32 s54, s54, 65536
s_add_u32 m0, s98, 4096
s_add_u32 s99, s54, 1048576
buffer_load_dwordx4 v20, s[32:35], s99 offen offset:0 lds
buffer_load_dwordx4 v20, s[32:35], s99 offen offset:1024 lds
buffer_load_dwordx4 v20, s[32:35], s99 offen offset:2048 lds
buffer_load_dwordx4 v20, s[32:35], s99 offen offset:3072 lds
s_add_u32 m0, s95, 1024
s_mov_b64 exec, 1
global_load_lds_dword v18, s[96:97]
s_mov_b64 exec, -1
s_waitcnt vmcnt(10)
L_fchk56:
ds_read_b32 v4, v13 offset:2184
s_waitcnt lgkmcnt(0)
v_cmp_ne_u32 vcc, 1, v4
s_nop 1
s_cbranch_vccz L_fok56
s_call_b64 s[92:93], L_pollstep
s_add_u32 s57, s57, 1
s_cmp_gt_u32 s57, 4194304
s_cbranch_scc1 L_fok56
s_branch L_fchk56
L_fok56:
s_add_u32 s54, s7, 1
s_and_b32 s54, s54, 3
s_mul_i32 s54, s54, 294912
s_add_u32 s54, s54, s51
s_add_u32 m0, s98, 135168
s_add_u32 s99, s54, 73728
buffer_load_dwordx4 v212, s[28:31], s99 offen offset:0 lds
buffer_load_dwordx4 v213, s[28:31], s99 offen offset:1024 lds
buffer_load_dwordx4 v214, s[28:31], s99 offen offset:2048 lds
buffer_load_dwordx4 v215, s[28:31], s99 offen offset:3072 lds
s_waitcnt vmcnt(10)
L_fchk57:
ds_read_b32 v4, v13 offset:2180
s_waitcnt lgkmcnt(0)
v_cmp_ne_u32 vcc, 1, v4
s_nop 1
s_cbranch_vccz L_fok57
s_call_b64 s[92:93], L_pollstep
s_add_u32 s57, s57, 1
s_cmp_gt_u32 s57, 4194304
s_cbranch_scc1 L_fok57
s_branch L_fchk57
L_fok57:
s_add_u32 s54, s7, 1
s_and_b32 s54, s54, 3
s_andn2_b32 s44, s9, 3
s_add_u32 s54, s54, s44
s_mul_i32 s54, s54, 65536
s_add_u32 m0, s98, 20480
s_add_u32 s99, s54, 1064960
buffer_load_dwordx4 v20, s[32:35], s99 offen offset:0 lds
buffer_load_dwordx4 v20, s[32:35], s99 offen offset:1024 lds
buffer_load_dwordx4 v20, s[32:35], s99 offen offset:2048 lds
buffer_load_dwordx4 v20, s[32:35], s99 offen offset:3072 lds
s_add_u32 m0, s95, 1088
s_mov_b64 exec, 3
global_load_lds_dword v18, s[96:97]
s_mov_b64 exec, -1
s_waitcnt vmcnt(10)
s_waitcnt vmcnt(14)
s_add_u32 s45, s56, 1
s_lshl_b32 s44, s9, 2
s_add_u32 s44, s44, s10
s_lshl_b32 s44, s44, 7
v_mov_b32 v4, s45
s_mov_b64 exec, 1
buffer_store_dword v4, v18, s[32:35], s44 offen offset:4 sc1
s_mov_b64 exec, -1
L_fchk59:
ds_read_b32 v4, v13 offset:2176
s_waitcnt lgkmcnt(0)
v_cmp_ne_u32 vcc, 1, v4
s_nop 1
s_cbranch_vccz L_fok59
s_call_b64 s[92:93], L_pollstep
s_add_u32 s57, s57, 1
s_cmp_gt_u32 s57, 4194304
s_cbranch_scc1 L_fok59
s_branch L_fchk59
L_fok59:
s_add_u32 s54, s7, 2
s_and_b32 s54, s54, 3
s_mul_i32 s54, s54, 294912
s_add_u32 s54, s54, s51
s_add_u32 m0, s98, 36864
s_add_u32 s99, s54, 0
buffer_load_dwordx4 v212, s[28:31], s99 offen offset:0 lds
buffer_load_dwordx4 v213, s[28:31], s99 offen offset:1024 lds
buffer_load_dwordx4 v214, s[28:31], s99 offen offset:2048 lds
buffer_load_dwordx4 v215, s[28:31], s99 offen offset:3072 lds
s_waitcnt vmcnt(10)
L_fchk60:
ds_read_b32 v4, v13 offset:2172
s_waitcnt lgkmcnt(0)
v_cmp_ne_u32 vcc, 1, v4
s_nop 1
s_cbranch_vccz L_fok60
s_call_b64 s[92:93], L_pollstep
s_add_u32 s57, s57, 1
s_cmp_gt_u32 s57, 4194304
s_cbranch_scc1 L_fok60
s_branch L_fchk60
L_fok60:
s_add_u32 s54, s7, 2
s_and_b32 s54, s54, 3
s_andn2_b32 s44, s9, 3
s_add_u32 s54, s54, s44
s_mul_i32 s54, s54, 65536
s_add_u32 m0, s98, 53248
s_add_u32 s99, s54, 1048576
buffer_load_dwordx4 v20, s[32:35], s99 offen offset:0 lds
buffer_load_dwordx4 v20, s[32:35], s99 offen offset:1024 lds
buffer_load_dwordx4 v20, s[32:35], s99 offen offset:2048 lds
buffer_load_dwordx4 v20, s[32:35], s99 offen offset:3072 lds
s_add_u32 m0, s95, 1152
s_mov_b64 exec, 3
global_load_lds_dword v18, s[96:97]
s_mov_b64 exec, -1
s_waitcnt vmcnt(10)
L_fchk61:
ds_read_b32 v4, v13 offset:2168
s_waitcnt lgkmcnt(0)
v_cmp_ne_u32 vcc, 1, v4
s_nop 1
s_cbranch_vccz L_fok61
s_call_b64 s[92:93], L_pollstep
s_add_u32 s57, s57, 1
s_cmp_gt_u32 s57, 4194304
s_cbranch_scc1 L_fok61
s_branch L_fchk61
L_fok61:
s_add_u32 s54, s7, 2
s_and_b32 s54, s54, 3
s_mul_i32 s54, s54, 294912
s_add_u32 s54, s54, s51
s_add_u32 m0, s98, 69632
s_add_u32 s99, s54, 73728
buffer_load_dwordx4 v212, s[28:31], s99 offen offset:0 lds
buffer_load_dwordx4 v213, s[28:31], s99 offen offset:1024 lds
buffer_load_dwordx4 v214, s[28:31], s99 offen offset:2048 lds
buffer_load_dwordx4 v215, s[28:31], s99 offen offset:3072 lds
s_waitcnt vmcnt(10)
L_fchk62:
ds_read_b32 v4, v13 offset:2164
s_waitcnt lgkmcnt(0)
v_cmp_ne_u32 vcc, 1, v4
s_nop 1
s_cbranch_vccz L_fok62
s_call_b64 s[92:93], L_pollstep
s_add_u32 s57, s57, 1
s_cmp_gt_u32 s57, 4194304
s_cbranch_scc1 L_fok62
s_branch L_fchk62
L_fok62:
s_add_u32 s54, s7, 2
s_and_b32 s54, s54, 3
s_andn2_b32 s44, s9, 3
s_add_u32 s54, s54, s44
s_mul_i32 s54, s54, 65536
s_add_u32 m0, s98, 86016
s_add_u32 s99, s54, 1064960
buffer_load_dwordx4 v20, s[32:35], s99 offen offset:0 lds
buffer_load_dwordx4 v20, s[32:35], s99 offen offset:1024 lds
buffer_load_dwordx4 v20, s[32:35], s99 offen offset:2048 lds
buffer_load_dwordx4 v20, s[32:35], s99 offen offset:3072 lds
s_add_u32 m0, s95, 1216
s_mov_b64 exec, 3
global_load_lds_dword v18, s[96:97]
s_mov_b64 exec, -1
s_waitcnt vmcnt(10)
L_fchk63:
ds_read_b32 v4, v13 offset:2160
s_waitcnt lgkmcnt(0)
v_cmp_ne_u32 vcc, 1, v4
s_nop 1
s_cbranch_vccz L_fok63
s_call_b64 s[92:93], L_pollstep
s_add_u32 s57, s57, 1
s_cmp_gt_u32 s57, 4194304
s_cbranch_scc1 L_fok63
s_branch L_fchk63
L_fok63:
s_add_u32 s54, s7, 3
s_and_b32 s54, s54, 3
s_mul_i32 s54, s54, 294912
s_add_u32 s54, s54, s51
s_add_u32 m0, s98, 102400
s_add_u32 s99, s54, 0
buffer_load_dwordx4 v212, s[28:31], s99 offen offset:0 lds
buffer_load_dwordx4 v213, s[28:31], s99 offen offset:1024 lds
buffer_load_dwordx4 v214, s[28:31], s99 offen offset:2048 lds
buffer_load_dwordx4 v215, s[28:31], s99 offen offset:3072 lds
s_waitcnt vmcnt(10)
L_fchk64:
ds_read_b32 v4, v13 offset:2156
s_waitcnt lgkmcnt(0)
v_cmp_ne_u32 vcc, 1, v4
s_nop 1
s_cbranch_vccz L_fok64
s_call_b64 s[92:93], L_pollstep
s_add_u32 s57, s57, 1
s_cmp_gt_u32 s57, 4194304
s_cbranch_scc1 L_fok64
s_branch L_fchk64
L_fok64:
s_add_u32 s54, s7, 3
s_and_b32 s54, s54, 3
s_andn2_b32 s44, s9, 3
s_add_u32 s54, s54, s44
s_mul_i32 s54, s54, 65536
s_add_u32 m0, s98, 4096
s_add_u32 s99, s54, 1048576
buffer_load_dwordx4 v20, s[32:35], s99 offen offset:0 lds
buffer_load_dwordx4 v20, s[32:35], s99 offen offset:1024 lds
buffer_load_dwordx4 v20, s[32:35], s99 offen offset:2048 lds
buffer_load_dwordx4 v20, s[32:35], s99 offen offset:3072 lds
s_add_u32 m0, s95, 1280
s_mov_b64 exec, 3
global_load_lds_dword v18, s[96:97]
s_mov_b64 exec, -1
s_waitcnt vmcnt(10)
L_fchk65:
ds_read_b32 v4, v13 offset:2152
s_waitcnt lgkmcnt(0)
v_cmp_ne_u32 vcc, 1, v4
s_nop 1
s_cbranch_vccz L_fok65
s_call_b64 s[92:93], L_pollstep
s_add_u32 s57, s57, 1
s_cmp_gt_u32 s57, 4194304
s_cbranch_scc1 L_fok65
s_branch L_fchk65
L_fok65:
s_add_u32 s54, s7, 3
s_and_b32 s54, s54, 3
s_mul_i32 s54, s54, 294912
s_add_u32 s54, s54, s51
s_add_u32 m0, s98, 118784
s_add_u32 s99, s54, 73728
buffer_load_dwordx4 v212, s[28:31], s99 offen offset:0 lds
buffer_load_dwordx4 v213, s[28:31], s99 offen offset:1024 lds
buffer_load_dwordx4 v214, s[28:31], s99 offen offset:2048 lds
buffer_load_dwordx4 v215, s[28:31], s99 offen offset:3072 lds
s_waitcnt vmcnt(10)
L_fchk66:
ds_read_b32 v4, v13 offset:2148
s_waitcnt lgkmcnt(0)
v_cmp_ne_u32 vcc, 1, v4
s_nop 1
s_cbranch_vccz L_fok66
s_call_b64 s[92:93], L_pollstep
s_add_u32 s57, s57, 1
s_cmp_gt_u32 s57, 4194304
s_cbranch_scc1 L_fok66
s_branch L_fchk66
L_fok66:
s_add_u32 s54, s7, 3
s_and_b32 s54, s54, 3
s_andn2_b32 s44, s9, 3
s_add_u32 s54, s54, s44
s_mul_i32 s54, s54, 65536
s_add_u32 m0, s98, 20480
s_add_u32 s99, s54, 1064960
buffer_load_dwordx4 v20, s[32:35], s99 offen offset:0 lds
buffer_load_dwordx4 v20, s[32:35], s99 offen offset:1024 lds
buffer_load_dwordx4 v20, s[32:35], s99 offen offset:2048 lds
buffer_load_dwordx4 v20, s[32:35], s99 offen offset:3072 lds
s_add_u32 m0, s95, 1344
s_mov_b64 exec, 3
global_load_lds_dword v18, s[96:97]
s_mov_b64 exec, -1
s_waitcnt vmcnt(10)
L_fchk67:
ds_read_b32 v4, v13 offset:2144
s_waitcnt lgkmcnt(0)
v_cmp_ne_u32 vcc, 1, v4
s_nop 1
s_cbranch_vccz L_fok67
s_call_b64 s[92:93], L_pollstep
s_add_u32 s57, s57, 1
s_cmp_gt_u32 s57, 4194304
s_cbranch_scc1 L_fok67
s_branch L_fchk67
L_fok67:
s_add_u32 s54, s7, 1
s_and_b32 s54, s54, 3
s_mul_i32 s54, s54, 294912
s_add_u32 s54, s54, s51
s_add_u32 m0, s98, 135168
s_add_u32 s99, s54, 147456
buffer_load_dwordx4 v212, s[28:31], s99 offen offset:0 lds
buffer_load_dwordx4 v213, s[28:31], s99 offen offset:1024 lds
buffer_load_dwordx4 v214, s[28:31], s99 offen offset:2048 lds
buffer_load_dwordx4 v215, s[28:31], s99 offen offset:3072 lds
s_waitcnt vmcnt(10)
L_fchk68:
ds_read_b32 v4, v13 offset:2140
s_waitcnt lgkmcnt(0)
v_cmp_ne_u32 vcc, 1, v4
s_nop 1
s_cbranch_vccz L_fok68
s_call_b64 s[92:93], L_pollstep
s_add_u32 s57, s57, 1
s_cmp_gt_u32 s57, 4194304
s_cbranch_scc1 L_fok68
s_branch L_fchk68
L_fok68:
L_rw68:
s_cmp_gt_u32 s94, 2
s_cbranch_scc1 L_rok68
s_call_b64 s[92:93], L_pollstep
s_add_u32 s57, s57, 1
s_cmp_gt_u32 s57, 4194304
s_cbranch_scc1 L_rok68
s_branch L_rw68
L_rok68:
s_add_u32 s54, s7, 1
s_and_b32 s54, s54, 3
s_andn2_b32 s44, s9, 3
s_add_u32 s54, s54, s44
s_mul_i32 s54, s54, 65536
s_add_u32 m0, s98, 53248
s_add_u32 s99, s54, 1081344
buffer_load_dwordx4 v20, s[32:35], s99 offen offset:0 lds
buffer_load_dwordx4 v20, s[32:35], s99 offen offset:1024 lds
buffer_load_dwordx4 v20, s[32:35], s99 offen offset:2048 lds
buffer_load_dwordx4 v20, s[32:35], s99 offen offset:3072 lds
s_add_u32 m0, s95, 1408
s_mov_b64 exec, 3
global_load_lds_dword v18, s[96:97]
s_mov_b64 exec, -1
s_waitcnt vmcnt(10)
L_fchk69:
ds_read_b32 v4, v13 offset:2136
s_waitcnt lgkmcnt(0)
v_cmp_ne_u32 vcc, 1, v4
s_nop 1
s_cbranch_vccz L_fok69
s_sleep 1
s_add_u32 s57, s57, 1
s_cmp_gt_u32 s57, 4194304
s_cbranch_scc1 L_fok69
s_branch L_fchk69
L_fok69:
s_add_u32 s54, s7, 2
s_and_b32 s54, s54, 3
s_andn2_b32 s44, s9, 3
s_add_u32 s54, s54, s44
s_mul_i32 s54, s54, 65536
s_add_u32 m0, s98, 36864
s_add_u32 s99, s54, 1081344
buffer_load_dwordx4 v20, s[32:35], s99 offen offset:0 lds
buffer_load_dwordx4 v20, s[32:35], s99 offen offset:1024 lds
buffer_load_dwordx4 v20, s[32:35], s99 offen offset:2048 lds
buffer_load_dwordx4 v20, s[32:35], s99 offen offset:3072 lds
s_add_u32 m0, s95, 1536
s_mov_b64 exec, 1
global_load_lds_dword v18, s[96:97]
s_mov_b64 exec, -1
s_waitcnt vmcnt(10)
L_fchk70:
ds_read_b32 v4, v13 offset:2132
s_waitcnt lgkmcnt(0)
v_cmp_ne_u32 vcc, 1, v4
s_nop 1
s_cbranch_vccz L_fok70
s_sleep 1
s_add_u32 s57, s57, 1
s_cmp_gt_u32 s57, 4194304
s_cbranch_scc1 L_fok70
s_branch L_fchk70
L_fok70:
s_add_u32 s54, s7, 1
s_and_b32 s54, s54, 3
s_mul_i32 s54, s54, 294912
s_add_u32 s54, s54, s51
s_add_u32 m0, s98, 86016
s_add_u32 s99, s54, 221184
buffer_load_dwordx4 v212, s[28:31], s99 offen offset:0 lds
buffer_load_dwordx4 v213, s[28:31], s99 offen offset:1024 lds
buffer_load_dwordx4 v214, s[28:31], s99 offen offset:2048 lds
buffer_load_dwordx4 v215, s[28:31], s99 offen offset:3072 lds
s_waitcnt vmcnt(10)
L_fchk71:
ds_read_b32 v4, v13 offset:2128
s_waitcnt lgkmcnt(0)
v_cmp_ne_u32 vcc, 1, v4
s_nop 1
s_cbranch_vccz L_fok71
s_sleep 1
s_add_u32 s57, s57, 1
s_cmp_gt_u32 s57, 4194304
s_cbranch_scc1 L_fok71
s_branch L_fchk71
L_fok71:
s_add_u32 s54, s7, 1
s_and_b32 s54, s54, 3
s_andn2_b32 s44, s9, 3
s_add_u32 s54, s54, s44
s_mul_i32 s54, s54, 65536
s_add_u32 m0, s98, 69632
s_add_u32 s99, s54, 1097728
buffer_load_dwordx4 v20, s[32:35], s99 offen offset:0 lds
buffer_load_dwordx4 v20, s[32:35], s99 offen offset:1024 lds
buffer_load_dwordx4 v20, s[32:35], s99 offen offset:2048 lds
buffer_load_dwordx4 v20, s[32:35], s99 offen offset:3072 lds
s_add_u32 m0, s95, 1472
s_mov_b64 exec, 3
global_load_lds_dword v18, s[96:97]
s_mov_b64 exec, -1
s_waitcnt vmcnt(10)
L_fchk72:
ds_read_b32 v4, v13 offset:2124
s_waitcnt lgkmcnt(0)
v_cmp_ne_u32 vcc, 1, v4
s_nop 1
s_cbranch_vccz L_fok72
s_sleep 1
s_add_u32 s57, s57, 1
s_cmp_gt_u32 s57, 4194304
s_cbranch_scc1 L_fok72
s_branch L_fchk72
L_fok72:
s_add_u32 s54, s7, 2
s_and_b32 s54, s54, 3
s_andn2_b32 s44, s9, 3
s_add_u32 s54, s54, s44
s_mul_i32 s54, s54, 65536
s_add_u32 m0, s98, 4096
s_add_u32 s99, s54, 1097728
buffer_load_dwordx4 v20, s[32:35], s99 offen offset:0 lds
buffer_load_dwordx4 v20, s[32:35], s99 offen offset:1024 lds
buffer_load_dwordx4 v20, s[32:35], s99 offen offset:2048 lds
buffer_load_dwordx4 v20, s[32:35], s99 offen offset:3072 lds
s_add_u32 m0, s95, 1568
s_mov_b64 exec, 3
global_load_lds_dword v18, s[96:97]
s_mov_b64 exec, -1
s_waitcnt vmcnt(10)
L_fchk73:
ds_read_b32 v4, v13 offset:2120
s_waitcnt lgkmcnt(0)
v_cmp_ne_u32 vcc, 1, v4
s_nop 1
s_cbranch_vccz L_fok73
s_sleep 1
s_add_u32 s57, s57, 1
s_cmp_gt_u32 s57, 4194304
s_cbranch_scc1 L_fok73
s_branch L_fchk73
L_fok73:
s_add_u32 s54, s7, 2
s_and_b32 s54, s54, 3
s_mul_i32 s54, s54, 294912
s_add_u32 s54, s54, s51
s_lshr_b32 s44, s5, 1
s_xor_b32 s44, s44, 1
s_lshl_b32 s44, s44, 7
s_add_u32 s54, s54, s44
s_add_u32 m0, s98, 102400
s_add_u32 s99, s54, 147456
buffer_load_dwordx4 v220, s[28:31], s99 offen offset:0 lds
buffer_load_dwordx4 v221, s[28:31], s99 offen offset:1024 lds
buffer_load_dwordx4 v222, s[28:31], s99 offen offset:2048 lds
buffer_load_dwordx4 v223, s[28:31], s99 offen offset:3072 lds
s_add_u32 m0, s95, 1540
s_mov_b64 exec, 1
global_load_lds_dword v18, s[96:97]
s_mov_b64 exec, -1
s_waitcnt vmcnt(10)
L_fchk74:
ds_read_b32 v4, v13 offset:2116
s_waitcnt lgkmcnt(0)
v_cmp_ne_u32 vcc, 1, v4
s_nop 1
s_cbranch_vccz L_fok74
s_sleep 1
s_add_u32 s57, s57, 1
s_cmp_gt_u32 s57, 4194304
s_cbranch_scc1 L_fok74
s_branch L_fchk74
L_fok74:
s_add_u32 s54, s7, 3
s_and_b32 s54, s54, 3
s_andn2_b32 s44, s9, 3
s_add_u32 s54, s54, s44
s_mul_i32 s54, s54, 65536
s_add_u32 m0, s98, 20480
s_add_u32 s99, s54, 1081344
buffer_load_dwordx4 v20, s[32:35], s99 offen offset:0 lds
buffer_load_dwordx4 v20, s[32:35], s99 offen offset:1024 lds
buffer_load_dwordx4 v20, s[32:35], s99 offen offset:2048 lds
buffer_load_dwordx4 v20, s[32:35], s99 offen offset:3072 lds
s_waitcnt vmcnt(10)
L_fchk75:
ds_read_b32 v4, v13 offset:2112
s_waitcnt lgkmcnt(0)
v_cmp_ne_u32 vcc, 1, v4
s_nop 1
s_cbranch_vccz L_fok75
s_sleep 1
s_add_u32 s57, s57, 1
s_cmp_gt_u32 s57, 4194304
s_cbranch_scc1 L_fok75
s_branch L_fchk75
L_fok75:
s_add_u32 s54, s7, 3
s_and_b32 s54, s54, 3
s_mul_i32 s54, s54, 294912
s_add_u32 s54, s54, s51
s_lshr_b32 s44, s5, 1
s_xor_b32 s44, s44, 1
s_lshl_b32 s44, s44, 7
s_add_u32 s54, s54, s44
s_add_u32 m0, s98, 118784
s_add_u32 s99, s54, 147456
buffer_load_dwordx4 v220, s[28:31], s99 offen offset:0 lds
buffer_load_dwordx4 v221, s[28:31], s99 offen offset:1024 lds
buffer_load_dwordx4 v222, s[28:31], s99 offen offset:2048 lds
buffer_load_dwordx4 v223, s[28:31], s99 offen offset:3072 lds
s_add_u32 m0, s95, 1600
s_mov_b64 exec, 3
global_load_lds_dword v18, s[96:97]
s_mov_b64 exec, -1
s_waitcnt vmcnt(10)
L_fchk76:
ds_read_b32 v4, v13 offset:2108
s_waitcnt lgkmcnt(0)
v_cmp_ne_u32 vcc, 1, v4
s_nop 1
s_cbranch_vccz L_fok76
s_sleep 1
s_add_u32 s57, s57, 1
s_cmp_gt_u32 s57, 4194304
s_cbranch_scc1 L_fok76
s_branch L_fchk76
L_fok76:
s_add_u32 s54, s7, 3
s_and_b32 s54, s54, 3
s_andn2_b32 s44, s9, 3
s_add_u32 s54, s54, s44
s_mul_i32 s54, s54, 65536
s_add_u32 m0, s98, 53248
s_add_u32 s99, s54, 1097728
buffer_load_dwordx4 v20, s[32:35], s99 offen offset:0 lds
buffer_load_dwordx4 v20, s[32:35], s99 offen offset:1024 lds
buffer_load_dwordx4 v20, s[32:35], s99 offen offset:2048 lds
buffer_load_dwordx4 v20, s[32:35], s99 offen offset:3072 lds
s_add_u32 m0, s95, 1632
s_mov_b64 exec, 3
global_load_lds_dword v18, s[96:97]
s_mov_b64 exec, -1
s_waitcnt vmcnt(10)
L_fchk77:
ds_read_b32 v4, v13 offset:2104
s_waitcnt lgkmcnt(0)
v_cmp_ne_u32 vcc, 1, v4
s_nop 1
s_cbranch_vccz L_fok77
s_sleep 1
s_add_u32 s57, s57, 1
s_cmp_gt_u32 s57, 4194304
s_cbranch_scc1 L_fok77
s_branch L_fchk77
L_fok77:
s_add_u32 s54, s7, 2
s_and_b32 s54, s54, 3
s_mul_i32 s54, s54, 294912
s_add_u32 s54, s54, s51
s_lshr_b32 s44, s5, 1
s_xor_b32 s44, s44, 0
s_lshl_b32 s44, s44, 7
s_add_u32 s54, s54, s44
s_add_u32 m0, s98, 135168
s_add_u32 s99, s54, 147456
buffer_load_dwordx4 v220, s[28:31], s99 offen offset:0 lds
buffer_load_dwordx4 v221, s[28:31], s99 offen offset:1024 lds
buffer_load_dwordx4 v222, s[28:31], s99 offen offset:2048 lds
buffer_load_dwordx4 v223, s[28:31], s99 offen offset:3072 lds
s_waitcnt vmcnt(10)
L_fchk78:
ds_read_b32 v4, v13 offset:2100
s_waitcnt lgkmcnt(0)
v_cmp_ne_u32 vcc, 1, v4
s_nop 1
s_cbranch_vccz L_fok78
s_sleep 1
s_add_u32 s57, s57, 1
s_cmp_gt_u32 s57, 4194304
s_cbranch_scc1 L_fok78
s_branch L_fchk78
L_fok78:
s_add_u32 s54, s7, 3
s_and_b32 s54, s54, 3
s_mul_i32 s54, s54, 294912
s_add_u32 s54, s54, s51
s_lshr_b32 s44, s5, 1
s_xor_b32 s44, s44, 0
s_lshl_b32 s44, s44, 7
s_add_u32 s54, s54, s44
s_add_u32 m0, s98, 69632
s_add_u32 s99, s54, 147456
buffer_load_dwordx4 v220, s[28:31], s99 offen offset:0 lds
buffer_load_dwordx4 v221, s[28:31], s99 offen offset:1024 lds
buffer_load_dwordx4 v222, s[28:31], s99 offen offset:2048 lds
buffer_load_dwordx4 v223, s[28:31], s99 offen offset:3072 lds
s_add_u32 m0, s95, 1696
s_mov_b64 exec, 3
global_load_lds_dword v18, s[96:97]
s_mov_b64 exec, -1
s_waitcnt vmcnt(10)
L_fchk79:
ds_read_b32 v4, v13 offset:2096
s_waitcnt lgkmcnt(0)
v_cmp_ne_u32 vcc, 1, v4
s_nop 1
s_cbranch_vccz L_fok79
s_sleep 1
s_add_u32 s57, s57, 1
s_cmp_gt_u32 s57, 4194304
s_cbranch_scc1 L_fok79
s_branch L_fchk79
L_fok79:
s_cmp_lg_u32 s10, 0
s_cbranch_scc1 L_l8skip
v_and_b32 v1, 15, v0
s_lshl_b32 s44, s8, 4
v_add_u32 v1, s44, v1
v_lshlrev_b32 v1, 2, v1
v_add_u32 v1, s7, v1
v_lshlrev_b32 v1, 7, v1
s_add_u32 s45, s56, 3
L_l8poll:
buffer_load_dword v2, v1, s[32:35], 0 offen sc1
s_waitcnt vmcnt(0)
v_subrev_u32 v2, s45, v2
v_cmp_lt_u32 vcc, 4, v2
s_nop 1
s_cbranch_vccz L_l8ok
s_sleep 2
s_add_u32 s57, s57, 1
s_cmp_gt_u32 s57, 4194304
s_cbranch_scc1 L_l8ok
s_branch L_l8poll
L_l8ok:
s_lshl_b32 s44, s9, 14
s_add_u32 s44, s44, 29360128
buffer_load_dwordx4 v[100:103], v12, s[32:35], s44 offen offset:0 sc1
buffer_load_dwordx4 v[104:107], v12, s[32:35], s44 offen offset:1024 sc1
buffer_load_dwordx4 v[108:111], v12, s[32:35], s44 offen offset:2048 sc1
buffer_load_dwordx4 v[112:115], v12, s[32:35], s44 offen offset:3072 sc1
s_add_u32 s44, s44, 4096
buffer_load_dwordx4 v[116:119], v12, s[32:35], s44 offen offset:0 sc1
buffer_load_dwordx4 v[120:123], v12, s[32:35], s44 offen offset:1024 sc1
buffer_load_dwordx4 v[124:127], v12, s[32:35], s44 offen offset:2048 sc1
buffer_load_dwordx4 v[128:131], v12, s[32:35], s44 offen offset:3072 sc1
s_add_u32 s44, s44, 4096
buffer_load_dwordx4 v[132:135], v12, s[32:35], s44 offen offset:0 sc1
buffer_load_dwordx4 v[136:139], v12, s[32:35], s44 offen offset:1024 sc1
buffer_load_dwordx4 v[140:143], v12, s[32:35], s44 offen offset:2048 sc1
buffer_load_dwordx4 v[144:147], v12, s[32:35], s44 offen offset:3072 sc1
s_add_u32 s44, s44, 4096
buffer_load_dwordx4 v[148:151], v12, s[32:35], s44 offen offset:0 sc1
buffer_load_dwordx4 v[152:155], v12, s[32:35], s44 offen offset:1024 sc1
buffer_load_dwordx4 v[156:159], v12, s[32:35], s44 offen offset:2048 sc1
buffer_load_dwordx4 v[160:163], v12, s[32:35], s44 offen offset:3072 sc1
L_l8skip:
s_waitcnt vmcnt(0)
v_add_u32 v5, 86016, v12
ds_write_b128 v5, v[32:35] offset:0
ds_write_b128 v5, v[36:39] offset:4096
ds_write_b128 v5, v[40:43] offset:8192
ds_write_b128 v5, v[44:47] offset:12288
L_fchk80:
ds_read_b32 v4, v13 offset:2092
s_waitcnt lgkmcnt(0)
v_cmp_ne_u32 vcc, 1, v4
s_nop 1
s_cbranch_vccz L_fok80
s_sleep 1
s_add_u32 s57, s57, 1
s_cmp_gt_u32 s57, 4194304
s_cbranch_scc1 L_fok80
s_branch L_fchk80
L_fok80:
v_add_u32 v5, 36864, v12
ds_write_b128 v5, v[48:51] offset:0
ds_write_b128 v5, v[52:55] offset:4096
s_mov_b64 exec, 1
ds_write_b64 v19, v[22:23] offset:1760
s_mov_b64 exec, -1
s_cmp_lg_u32 s10, 0
s_cbranch_scc1 L_ldone
v_and_b32 v1, 31, v0
v_lshrrev_b32 v2, 5, v0
v_and_b32 v5, 19, v1
v_bfe_u32 v6, v1, 2, 1
v_lshl_add_u32 v5, v6, 3, v5
v_bfe_u32 v6, v1, 3, 1
v_lshl_add_u32 v5, v6, 2, v5
v_mul_u32_u24 v6, 9216, v2
v_lshl_add_u32 v9, v5, 1, v6
s_lshl_b32 s44, s6, 2
s_add_u32 s44, s44, s7
s_lshl_b32 s44, s44, 2
s_add_u32 s44, s44, s5
s_mul_i32 s44, s44, 18432
s_mul_i32 s45, s4, 1152
s_add_u32 s44, s44, s45
s_add_u32 s44, s44, 1024
v_lshlrev_b32 v90, 16, v100
v_and_b32 v91, 0xffff0000, v100
v_lshlrev_b32 v92, 16, v101
v_and_b32 v93, 0xffff0000, v101
v_lshlrev_b32 v94, 16, v102
v_and_b32 v95, 0xffff0000, v102
v_lshlrev_b32 v96, 16, v103
v_and_b32 v97, 0xffff0000, v103
v_lshlrev_b32 v2, 16, v104
v_and_b32 v3, 0xffff0000, v104
v_pk_add_f32 v[90:91], v[90:91], v[2:3]
v_lshlrev_b32 v2, 16, v105
v_and_b32 v3, 0xffff0000, v105
v_pk_add_f32 v[92:93], v[92:93], v[2:3]
v_lshlrev_b32 v2, 16, v106
v_and_b32 v3, 0xffff0000, v106
v_pk_add_f32 v[94:95], v[94:95], v[2:3]
v_lshlrev_b32 v2, 16, v107
v_and_b32 v3, 0xffff0000, v107
v_pk_add_f32 v[96:97], v[96:97], v[2:3]
v_lshlrev_b32 v2, 16, v108
v_and_b32 v3, 0xffff0000, v108
v_pk_add_f32 v[90:91], v[90:91], v[2:3]
v_lshlrev_b32 v2, 16, v109
v_and_b32 v3, 0xffff0000, v109
v_pk_add_f32 v[92:93], v[92:93], v[2:3]
v_lshlrev_b32 v2, 16, v110
v_and_b32 v3, 0xffff0000, v110
v_pk_add_f32 v[94:95], v[94:95], v[2:3]
v_lshlrev_b32 v2, 16, v111
v_and_b32 v3, 0xffff0000, v111
v_pk_add_f32 v[96:97], v[96:97], v[2:3]
v_lshlrev_b32 v2, 16, v112
v_and_b32 v3, 0xffff0000, v112
v_pk_add_f32 v[90:91], v[90:91], v[2:3]
v_lshlrev_b32 v2, 16, v113
v_and_b32 v3, 0xffff0000, v113
v_pk_add_f32 v[92:93], v[92:93], v[2:3]
v_lshlrev_b32 v2, 16, v114
v_and_b32 v3, 0xffff0000, v114
v_pk_add_f32 v[94:95], v[94:95], v[2:3]
v_lshlrev_b32 v2, 16, v115
v_and_b32 v3, 0xffff0000, v115
v_pk_add_f32 v[96:97], v[96:97], v[2:3]
v_lshlrev_b32 v2, 16, v116
v_and_b32 v3, 0xffff0000, v116
v_pk_add_f32 v[90:91], v[90:91], v[2:3]
v_lshlrev_b32 v2, 16, v117
v_and_b32 v3, 0xffff0000, v117
v_pk_add_f32 v[92:93], v[92:93], v[2:3]
v_lshlrev_b32 v2, 16, v118
v_and_b32 v3, 0xffff0000, v118
v_pk_add_f32 v[94:95], v[94:95], v[2:3]
v_lshlrev_b32 v2, 16, v119
v_and_b32 v3, 0xffff0000, v119
v_pk_add_f32 v[96:97], v[96:97], v[2:3]
v_lshlrev_b32 v2, 16, v120
v_and_b32 v3, 0xffff0000, v120
v_pk_add_f32 v[90:91], v[90:91], v[2:3]
v_lshlrev_b32 v2, 16, v121
v_and_b32 v3, 0xffff0000, v121
v_pk_add_f32 v[92:93], v[92:93], v[2:3]
v_lshlrev_b32 v2, 16, v122
v_and_b32 v3, 0xffff0000, v122
v_pk_add_f32 v[94:95], v[94:95], v[2:3]
v_lshlrev_b32 v2, 16, v123
v_and_b32 v3, 0xffff0000, v123
v_pk_add_f32 v[96:97], v[96:97], v[2:3]
v_lshlrev_b32 v2, 16, v124
v_and_b32 v3, 0xffff0000, v124
v_pk_add_f32 v[90:91], v[90:91], v[2:3]
v_lshlrev_b32 v2, 16, v125
v_and_b32 v3, 0xffff0000, v125
v_pk_add_f32 v[92:93], v[92:93], v[2:3]
v_lshlrev_b32 v2, 16, v126
v_and_b32 v3, 0xffff0000, v126
v_pk_add_f32 v[94:95], v[94:95], v[2:3]
v_lshlrev_b32 v2, 16, v127
v_and_b32 v3, 0xffff0000, v127
v_pk_add_f32 v[96:97], v[96:97], v[2:3]
v_lshlrev_b32 v2, 16, v128
v_and_b32 v3, 0xffff0000, v128
v_pk_add_f32 v[90:91], v[90:91], v[2:3]
v_lshlrev_b32 v2, 16, v129
v_and_b32 v3, 0xffff0000, v129
v_pk_add_f32 v[92:93], v[92:93], v[2:3]
v_lshlrev_b32 v2, 16, v130
v_and_b32 v3, 0xffff0000, v130
v_pk_add_f32 v[94:95], v[94:95], v[2:3]
v_lshlrev_b32 v2, 16, v131
v_and_b32 v3, 0xffff0000, v131
v_pk_add_f32 v[96:97], v[96:97], v[2:3]
v_lshlrev_b32 v2, 16, v132
v_and_b32 v3, 0xffff0000, v132
v_pk_add_f32 v[90:91], v[90:91], v[2:3]
v_lshlrev_b32 v2, 16, v133
v_and_b32 v3, 0xffff0000, v133
v_pk_add_f32 v[92:93], v[92:93], v[2:3]
v_lshlrev_b32 v2, 16, v134
v_and_b32 v3, 0xffff0000, v134
v_pk_add_f32 v[94:95], v[94:95], v[2:3]
v_lshlrev_b32 v2, 16, v135
v_and_b32 v3, 0xffff0000, v135
v_pk_add_f32 v[96:97], v[96:97], v[2:3]
v_lshlrev_b32 v2, 16, v136
v_and_b32 v3, 0xffff0000, v136
v_pk_add_f32 v[90:91], v[90:91], v[2:3]
v_lshlrev_b32 v2, 16, v137
v_and_b32 v3, 0xffff0000, v137
v_pk_add_f32 v[92:93], v[92:93], v[2:3]
v_lshlrev_b32 v2, 16, v138
v_and_b32 v3, 0xffff0000, v138
v_pk_add_f32 v[94:95], v[94:95], v[2:3]
v_lshlrev_b32 v2, 16, v139
v_and_b32 v3, 0xffff0000, v139
v_pk_add_f32 v[96:97], v[96:97], v[2:3]
v_lshlrev_b32 v2, 16, v140
v_and_b32 v3, 0xffff0000, v140
v_pk_add_f32 v[90:91], v[90:91], v[2:3]
v_lshlrev_b32 v2, 16, v141
v_and_b32 v3, 0xffff0000, v141
v_pk_add_f32 v[92:93], v[92:93], v[2:3]
v_lshlrev_b32 v2, 16, v142
v_and_b32 v3, 0xffff0000, v142
v_pk_add_f32 v[94:95], v[94:95], v[2:3]
v_lshlrev_b32 v2, 16, v143
v_and_b32 v3, 0xffff0000, v143
v_pk_add_f32 v[96:97], v[96:97], v[2:3]
v_lshlrev_b32 v2, 16, v144
v_and_b32 v3, 0xffff0000, v144
v_pk_add_f32 v[90:91], v[90:91], v[2:3]
v_lshlrev_b32 v2, 16, v145
v_and_b32 v3, 0xffff0000, v145
v_pk_add_f32 v[92:93], v[92:93], v[2:3]
v_lshlrev_b32 v2, 16, v146
v_and_b32 v3, 0xffff0000, v146
v_pk_add_f32 v[94:95], v[94:95], v[2:3]
v_lshlrev_b32 v2, 16, v147
v_and_b32 v3, 0xffff0000, v147
v_pk_add_f32 v[96:97], v[96:97], v[2:3]
v_lshlrev_b32 v2, 16, v148
v_and_b32 v3, 0xffff0000, v148
v_pk_add_f32 v[90:91], v[90:91], v[2:3]
v_lshlrev_b32 v2, 16, v149
v_and_b32 v3, 0xffff0000, v149
v_pk_add_f32 v[92:93], v[92:93], v[2:3]
v_lshlrev_b32 v2, 16, v150
v_and_b32 v3, 0xffff0000, v150
v_pk_add_f32 v[94:95], v[94:95], v[2:3]
v_lshlrev_b32 v2, 16, v151
v_and_b32 v3, 0xffff0000, v151
v_pk_add_f32 v[96:97], v[96:97], v[2:3]
v_lshlrev_b32 v2, 16, v152
v_and_b32 v3, 0xffff0000, v152
v_pk_add_f32 v[90:91], v[90:91], v[2:3]
v_lshlrev_b32 v2, 16, v153
v_and_b32 v3, 0xffff0000, v153
v_pk_add_f32 v[92:93], v[92:93], v[2:3]
v_lshlrev_b32 v2, 16, v154
v_and_b32 v3, 0xffff0000, v154
v_pk_add_f32 v[94:95], v[94:95], v[2:3]
v_lshlrev_b32 v2, 16, v155
v_and_b32 v3, 0xffff0000, v155
v_pk_add_f32 v[96:97], v[96:97], v[2:3]
v_lshlrev_b32 v2, 16, v156
v_and_b32 v3, 0xffff0000, v156
v_pk_add_f32 v[90:91], v[90:91], v[2:3]
v_lshlrev_b32 v2, 16, v157
v_and_b32 v3, 0xffff0000, v157
v_pk_add_f32 v[92:93], v[92:93], v[2:3]
v_lshlrev_b32 v2, 16, v158
v_and_b32 v3, 0xffff0000, v158
v_pk_add_f32 v[94:95], v[94:95], v[2:3]
v_lshlrev_b32 v2, 16, v159
v_and_b32 v3, 0xffff0000, v159
v_pk_add_f32 v[96:97], v[96:97], v[2:3]
v_lshlrev_b32 v2, 16, v160
v_and_b32 v3, 0xffff0000, v160
v_pk_add_f32 v[90:91], v[90:91], v[2:3]
v_lshlrev_b32 v2, 16, v161
v_and_b32 v3, 0xffff0000, v161
v_pk_add_f32 v[92:93], v[92:93], v[2:3]
v_lshlrev_b32 v2, 16, v162
v_and_b32 v3, 0xffff0000, v162
v_pk_add_f32 v[94:95], v[94:95], v[2:3]
v_lshlrev_b32 v2, 16, v163
v_and_b32 v3, 0xffff0000, v163
v_pk_add_f32 v[96:97], v[96:97], v[2:3]
v_cvt_pk_bf16_f32 v4, v90, v91
s_add_u32 s45, s44, 0
buffer_store_short v4, v9, s[36:39], s45 offen offset:0
buffer_store_short_d16_hi v4, v9, s[36:39], s45 offen offset:2304
v_cvt_pk_bf16_f32 v5, v92, v93
s_add_u32 s45, s44, 4608
buffer_store_short v5, v9, s[36:39], s45 offen offset:0
buffer_store_short_d16_hi v5, v9, s[36:39], s45 offen offset:2304
v_cvt_pk_bf16_f32 v6, v94, v95
s_add_u32 s45, s44, 0
buffer_store_short v6, v9, s[36:39], s45 offen offset:64
buffer_store_short_d16_hi v6, v9, s[36:39], s45 offen offset:2368
v_cvt_pk_bf16_f32 v7, v96, v97
s_add_u32 s45, s44, 4608
buffer_store_short v7, v9, s[36:39], s45 offen offset:64
buffer_store_short_d16_hi v7, v9, s[36:39], s45 offen offset:2368
L_ldone:
s_endpgm
L_pollstep:
s_sleep 2
s_cmp_ge_u32 s94, 3
s_cbranch_scc1 L_pret
s_add_u32 s101, s101, 1
s_mov_b64 exec, 15
s_and_b32 s45, s101, 15
s_cbranch_scc1 L_pfast
buffer_load_dword v15, v11, s[32:35], 0 offen sc1
s_branch L_pwait
L_pfast:
s_mov_b32 s44, 262144
buffer_load_dword v16, v11, s[32:35], s44 offen sc1
L_pwait:
s_waitcnt vmcnt(0)
L_pagain:
s_mov_b64 exec, 15
s_add_u32 s45, s56, s94
s_sub_u32 s47, 7, s94
v_subrev_u32 v4, s45, v15
v_subrev_u32 v5, s45, v16
v_min_u32 v4, v4, v5
v_cmp_lt_u32 vcc, s47, v4
s_mov_b64 exec, -1
s_nop 0
s_cbranch_vccnz L_pret
s_add_u32 s94, s94, 1
s_cmp_lt_u32 s94, 3
s_cbranch_scc1 L_pagain
L_pret:
s_setpc_b64 s[92:93]
L_waittag:
s_lshl_b32 s44, s8, 2
L_wrtag:
buffer_load_dword v4, v18, s[40:43], s44 offen sc1
s_waitcnt vmcnt(0)
v_readfirstlane_b32 s56, v4
s_nop 1
s_cmp_lg_u32 s56, 0
s_cbranch_scc1 L_wrret
s_add_u32 s57, s57, 1
s_cmp_gt_u32 s57, 4194304
s_cbranch_scc1 L_wrret
s_branch L_wrtag
L_wrret:
s_setpc_b64 s[92:93]
.p2align 6
L_compute:
s_setprio 3
s_and_b32 s5, s2, 3
s_bfe_u32 s7, s2, 0x20003
v_mov_b32 v235, 0
v_and_b32 v1, 31, v0
v_lshrrev_b32 v2, 5, v0
v_bfe_u32 v3, v0, 2, 2
v_and_b32 v4, 1, v0
v_lshlrev_b32 v4, 1, v4
v_bfe_u32 v5, v0, 1, 1
v_or_b32 v4, v4, v5
v_bfe_u32 v5, v0, 4, 1
v_lshl_add_u32 v4, v5, 2, v4
v_lshlrev_b32 v4, 3, v4
v_lshl_add_u32 v4, v3, 6, v4
v_lshl_add_u32 v228, v2, 11, v4
v_lshl_add_u32 v229, v2, 10, v4
v_lshrrev_b32 v6, 3, v1
v_lshlrev_b32 v6, 10, v6
v_and_b32 v7, 7, v1
v_lshl_add_u32 v6, v7, 6, v6
v_xor_b32 v7, v3, v2
v_lshl_add_u32 v6, v7, 4, v6
s_lshl_b32 s44, s10, 12
v_add_u32 v230, s44, v6
v_xor_b32 v231, 32, v230
v_lshl_add_u32 v237, v0, 4, s44
v_and_b32 v6, 7, v0
v_lshlrev_b32 v236, 2, v6
s_mul_i32 s44, s10, 516
s_add_u32 m0, s44, 2032
v_and_b32 v5, 19, v1
v_bfe_u32 v6, v1, 2, 1
v_lshl_add_u32 v5, v6, 3, v5
v_bfe_u32 v6, v1, 3, 1
v_lshl_add_u32 v5, v6, 2, v5
v_lshrrev_b32 v6, 2, v5
v_lshlrev_b32 v7, 10, v6
v_and_b32 v8, 3, v5
v_lshl_add_u32 v7, v8, 6, v7
v_and_b32 v6, 3, v6
v_xor_b32 v6, v6, v2
v_lshl_add_u32 v232, v6, 4, v7
v_xor_b32 v233, 32, v232
v_mul_u32_u24 v6, 9216, v2
v_lshl_add_u32 v255, v5, 1, v6
s_mov_b32 s58, 0x3e0293ee
s_bfe_u32 s4, s2, 0x10002
s_lshl_b32 s8, s4, 3
s_add_u32 s8, s8, s6
s_lshl_b32 s9, s8, 2
s_add_u32 s9, s9, s5
s_lshl_b32 s9, s9, 2
s_add_u32 s9, s9, s7
s_mov_b32 s57, 0
s_mov_b32 s34, 268435456
s_mov_b32 s35, 0x20000
s_mov_b64 s[36:37], s[68:69]
s_mov_b32 s38, 2359296
s_mov_b32 s39, 0x20000
s_mov_b64 s[40:41], s[70:71]
s_mov_b32 s42, 256
s_mov_b32 s43, 0x20000
s_mul_i32 s48, s9, 65536
s_add_u32 s48, s48, 1048576
s_lshl_b32 s53, s9, 15
s_add_u32 s53, s53, 20971520
s_andn2_b32 s50, s9, 12
s_lshl_b32 s50, s50, 15
s_add_u32 s50, s50, 20971520
s_lshl_b32 s49, s9, 2
s_add_u32 s49, s49, s10
s_lshl_b32 s49, s49, 7
s_lshl_b32 s51, s8, 4
s_add_u32 s51, s51, s10
s_lshl_b32 s51, s51, 4
s_and_b32 s44, s9, 15
s_add_u32 s51, s51, s44
s_sub_u32 s51, s51, s10
s_lshl_b32 s51, s51, 10
s_add_u32 s51, s51, 29360128
s_lshl_b32 s52, s6, 2
s_add_u32 s52, s52, s10
s_mul_i32 s52, s52, 73728
s_mul_i32 s44, s4, 1152
s_add_u32 s52, s52, s44
s_lshl_b32 s44, s7, 8
s_add_u32 s52, s52, s44
s_lshl_b32 s44, s5, 6
s_add_u32 s52, s52, s44
s_lshl_b32 s59, s8, 2
s_and_b32 s54, s9, 15
s_or_b32 s54, s54, s3
s_cmp_lg_u32 s54, 0
s_cbranch_scc1 L_noscan
v_lshlrev_b32 v1, 7, v0
s_lshl_b32 s44, s8, 13
buffer_load_dwordx2 v[244:245], v1, s[32:35], s44 offen sc1
s_add_u32 s44, s44, 262144
buffer_load_dword v246, v1, s[32:35], s44 offen sc1
L_noscan:
ds_read_b32 v238, v236 offset:0
s_waitcnt lgkmcnt(0)
v_cmp_ne_u32 vcc, 1, v238
s_nop 0
s_cbranch_vccnz L_spin0
L_back0:
v_add_u32 v239, 4096, v230
ds_read_b128 v[160:163], v239 offset:0
v_add_u32 v240, 20480, v228
ds_read_b64_tr_b16 v[192:193], v240 offset:0
ds_read_b64_tr_b16 v[194:195], v240 offset:1024
ds_read_b64_tr_b16 v[196:197], v240 offset:256
ds_read_b64_tr_b16 v[198:199], v240 offset:1280
ds_read_b64_tr_b16 v[200:201], v240 offset:512
ds_read_b64_tr_b16 v[202:203], v240 offset:1536
ds_read_b64_tr_b16 v[204:205], v240 offset:768
ds_read_b64_tr_b16 v[206:207], v240 offset:1792
s_waitcnt lgkmcnt(4)
v_mfma_f32_32x32x16_bf16 v[0:15], v[192:195], v[160:163], 0
ds_read_b64_tr_b16 v[208:209], v240 offset:8192
ds_read_b64_tr_b16 v[210:211], v240 offset:9216
v_mfma_f32_32x32x16_bf16 v[16:31], v[196:199], v[160:163], 0
ds_read_b64_tr_b16 v[212:213], v240 offset:8448
ds_read_b64_tr_b16 v[214:215], v240 offset:9472
s_waitcnt lgkmcnt(4)
v_mfma_f32_32x32x16_bf16 v[32:47], v[200:203], v[160:163], 0
ds_read_b64_tr_b16 v[192:193], v240 offset:8704
ds_read_b64_tr_b16 v[194:195], v240 offset:9728
ds_read_b128 v[168:171], v239 offset:512
v_mfma_f32_32x32x16_bf16 v[48:63], v[204:207], v[160:163], 0
ds_read_b64_tr_b16 v[196:197], v240 offset:8960
ds_read_b64_tr_b16 v[198:199], v240 offset:9984
s_waitcnt lgkmcnt(5)
v_mfma_f32_32x32x16_bf16 v[64:79], v[208:211], v[160:163], 0
v_add_u32 v241, 4096, v231
ds_read_b128 v[164:167], v241 offset:0
ds_read_b64_tr_b16 v[200:201], v240 offset:4096
ds_read_b64_tr_b16 v[202:203], v240 offset:5120
v_mfma_f32_32x32x16_bf16 v[80:95], v[212:215], v[160:163], 0
ds_read_b64_tr_b16 v[204:205], v240 offset:4352
ds_read_b64_tr_b16 v[206:207], v240 offset:5376
s_waitcnt lgkmcnt(5)
v_mfma_f32_32x32x16_bf16 v[96:111], v[192:195], v[160:163], 0
ds_read_b64_tr_b16 v[208:209], v240 offset:4608
ds_read_b64_tr_b16 v[210:211], v240 offset:5632
v_mfma_f32_32x32x16_bf16 v[112:127], v[196:199], v[160:163], 0
ds_read_b64_tr_b16 v[212:213], v240 offset:4864
ds_read_b64_tr_b16 v[214:215], v240 offset:5888
s_waitcnt lgkmcnt(4)
v_mfma_f32_32x32x16_bf16 v[0:15], v[200:203], v[164:167], v[0:15]
ds_read_b64_tr_b16 v[192:193], v240 offset:12288
ds_read_b64_tr_b16 v[194:195], v240 offset:13312
v_mfma_f32_32x32x16_bf16 v[16:31], v[204:207], v[164:167], v[16:31]
ds_read_b32 v238, v236 offset:32
ds_read_b64_tr_b16 v[196:197], v240 offset:12544
ds_read_b64_tr_b16 v[198:199], v240 offset:13568
s_waitcnt lgkmcnt(5)
v_mfma_f32_32x32x16_bf16 v[32:47], v[208:211], v[164:167], v[32:47]
ds_read_b64_tr_b16 v[200:201], v240 offset:12800
ds_read_b64_tr_b16 v[202:203], v240 offset:13824
ds_read_b128 v[172:175], v241 offset:512
v_mfma_f32_32x32x16_bf16 v[48:63], v[212:215], v[164:167], v[48:63]
ds_read_b64_tr_b16 v[204:205], v240 offset:13056
ds_read_b64_tr_b16 v[206:207], v240 offset:14080
s_waitcnt lgkmcnt(5)
v_mfma_f32_32x32x16_bf16 v[64:79], v[192:195], v[164:167], v[64:79]
v_cmp_ne_u32 vcc, 1, v238
s_nop 0
s_cbranch_vccnz L_spin1
L_back1:
v_add_u32 v242, 36864, v228
ds_read_b64_tr_b16 v[208:209], v242 offset:0
ds_read_b64_tr_b16 v[210:211], v242 offset:1024
v_mfma_f32_32x32x16_bf16 v[80:95], v[196:199], v[164:167], v[80:95]
ds_read_b64_tr_b16 v[212:213], v242 offset:256
ds_read_b64_tr_b16 v[214:215], v242 offset:1280
s_waitcnt lgkmcnt(4)
v_mfma_f32_32x32x16_bf16 v[96:111], v[200:203], v[164:167], v[96:111]
ds_read_b64_tr_b16 v[192:193], v242 offset:512
ds_read_b64_tr_b16 v[194:195], v242 offset:1536
v_mfma_f32_32x32x16_bf16 v[112:127], v[204:207], v[164:167], v[112:127]
global_load_lds_dword v235, s[96:97] offset:252
ds_read_b64_tr_b16 v[196:197], v242 offset:768
ds_read_b64_tr_b16 v[198:199], v242 offset:1792
s_waitcnt lgkmcnt(4)
v_mfma_f32_32x32x16_bf16 v[0:15], v[208:211], v[168:171], v[0:15]
ds_read_b64_tr_b16 v[200:201], v242 offset:8192
ds_read_b64_tr_b16 v[202:203], v242 offset:9216
v_mfma_f32_32x32x16_bf16 v[16:31], v[212:215], v[168:171], v[16:31]
ds_read_b64_tr_b16 v[204:205], v242 offset:8448
ds_read_b64_tr_b16 v[206:207], v242 offset:9472
s_waitcnt lgkmcnt(4)
v_mfma_f32_32x32x16_bf16 v[32:47], v[192:195], v[168:171], v[32:47]
ds_read_b64_tr_b16 v[208:209], v242 offset:8704
ds_read_b64_tr_b16 v[210:211], v242 offset:9728
v_mfma_f32_32x32x16_bf16 v[48:63], v[196:199], v[168:171], v[48:63]
ds_read_b64_tr_b16 v[212:213], v242 offset:8960
ds_read_b64_tr_b16 v[214:215], v242 offset:9984
s_waitcnt lgkmcnt(4)
v_mfma_f32_32x32x16_bf16 v[64:79], v[200:203], v[168:171], v[64:79]
ds_read_b64_tr_b16 v[192:193], v242 offset:4096
ds_read_b64_tr_b16 v[194:195], v242 offset:5120
v_mfma_f32_32x32x16_bf16 v[80:95], v[204:207], v[168:171], v[80:95]
ds_read_b64_tr_b16 v[196:197], v242 offset:4352
ds_read_b64_tr_b16 v[198:199], v242 offset:5376
s_waitcnt lgkmcnt(4)
v_mfma_f32_32x32x16_bf16 v[96:111], v[208:211], v[168:171], v[96:111]
ds_read_b64_tr_b16 v[200:201], v242 offset:4608
ds_read_b64_tr_b16 v[202:203], v242 offset:5632
v_mfma_f32_32x32x16_bf16 v[112:127], v[212:215], v[168:171], v[112:127]
ds_read_b64_tr_b16 v[204:205], v242 offset:4864
ds_read_b64_tr_b16 v[206:207], v242 offset:5888
s_waitcnt lgkmcnt(4)
v_mfma_f32_32x32x16_bf16 v[0:15], v[192:195], v[172:175], v[0:15]
ds_read_b64_tr_b16 v[208:209], v242 offset:12288
ds_read_b64_tr_b16 v[210:211], v242 offset:13312
v_mfma_f32_32x32x16_bf16 v[16:31], v[196:199], v[172:175], v[16:31]
ds_read_b32 v238, v236 offset:64
ds_read_b64_tr_b16 v[212:213], v242 offset:12544
ds_read_b64_tr_b16 v[214:215], v242 offset:13568
s_waitcnt lgkmcnt(5)
v_mfma_f32_32x32x16_bf16 v[32:47], v[200:203], v[172:175], v[32:47]
ds_read_b64_tr_b16 v[192:193], v242 offset:12800
ds_read_b64_tr_b16 v[194:195], v242 offset:13824
v_mfma_f32_32x32x16_bf16 v[48:63], v[204:207], v[172:175], v[48:63]
ds_read_b64_tr_b16 v[196:197], v242 offset:13056
ds_read_b64_tr_b16 v[198:199], v242 offset:14080
s_waitcnt lgkmcnt(4)
v_mfma_f32_32x32x16_bf16 v[64:79], v[208:211], v[172:175], v[64:79]
v_cmp_ne_u32 vcc, 1, v238
s_nop 0
s_cbranch_vccnz L_spin2
L_back2:
v_add_u32 v243, 53248, v230
ds_read_b128 v[176:179], v243 offset:0
v_add_u32 v239, 69632, v228
ds_read_b64_tr_b16 v[200:201], v239 offset:0
ds_read_b64_tr_b16 v[202:203], v239 offset:1024
v_mfma_f32_32x32x16_bf16 v[80:95], v[212:215], v[172:175], v[80:95]
ds_read_b64_tr_b16 v[204:205], v239 offset:256
ds_read_b64_tr_b16 v[206:207], v239 offset:1280
s_waitcnt lgkmcnt(5)
v_mfma_f32_32x32x16_bf16 v[96:111], v[192:195], v[172:175], v[96:111]
ds_read_b64_tr_b16 v[208:209], v239 offset:512
ds_read_b64_tr_b16 v[210:211], v239 offset:1536
v_mfma_f32_32x32x16_bf16 v[112:127], v[196:199], v[172:175], v[112:127]
global_load_lds_dword v235, s[96:97] offset:248
ds_read_b64_tr_b16 v[212:213], v239 offset:768
ds_read_b64_tr_b16 v[214:215], v239 offset:1792
s_waitcnt lgkmcnt(4)
v_mfma_f32_32x32x16_bf16 v[0:15], v[200:203], v[176:179], v[0:15]
ds_read_b64_tr_b16 v[192:193], v239 offset:8192
ds_read_b64_tr_b16 v[194:195], v239 offset:9216
v_mfma_f32_32x32x16_bf16 v[16:31], v[204:207], v[176:179], v[16:31]
ds_read_b64_tr_b16 v[196:197], v239 offset:8448
ds_read_b64_tr_b16 v[198:199], v239 offset:9472
s_waitcnt lgkmcnt(4)
v_mfma_f32_32x32x16_bf16 v[32:47], v[208:211], v[176:179], v[32:47]
ds_read_b64_tr_b16 v[200:201], v239 offset:8704
ds_read_b64_tr_b16 v[202:203], v239 offset:9728
ds_read_b128 v[184:187], v243 offset:512
v_mfma_f32_32x32x16_bf16 v[48:63], v[212:215], v[176:179], v[48:63]
ds_read_b64_tr_b16 v[204:205], v239 offset:8960
ds_read_b64_tr_b16 v[206:207], v239 offset:9984
s_waitcnt lgkmcnt(5)
v_mfma_f32_32x32x16_bf16 v[64:79], v[192:195], v[176:179], v[64:79]
v_add_u32 v240, 53248, v231
ds_read_b128 v[180:183], v240 offset:0
ds_read_b64_tr_b16 v[208:209], v239 offset:4096
ds_read_b64_tr_b16 v[210:211], v239 offset:5120
v_mfma_f32_32x32x16_bf16 v[80:95], v[196:199], v[176:179], v[80:95]
ds_read_b64_tr_b16 v[212:213], v239 offset:4352
ds_read_b64_tr_b16 v[214:215], v239 offset:5376
s_waitcnt lgkmcnt(5)
v_mfma_f32_32x32x16_bf16 v[96:111], v[200:203], v[176:179], v[96:111]
ds_read_b64_tr_b16 v[192:193], v239 offset:4608
ds_read_b64_tr_b16 v[194:195], v239 offset:5632
v_mfma_f32_32x32x16_bf16 v[112:127], v[204:207], v[176:179], v[112:127]
ds_read_b64_tr_b16 v[196:197], v239 offset:4864
ds_read_b64_tr_b16 v[198:199], v239 offset:5888
s_waitcnt lgkmcnt(4)
v_mfma_f32_32x32x16_bf16 v[0:15], v[208:211], v[180:183], v[0:15]
ds_read_b64_tr_b16 v[200:201], v239 offset:12288
ds_read_b64_tr_b16 v[202:203], v239 offset:13312
v_mfma_f32_32x32x16_bf16 v[16:31], v[212:215], v[180:183], v[16:31]
ds_read_b32 v238, v236 offset:96
ds_read_b64_tr_b16 v[204:205], v239 offset:12544
ds_read_b64_tr_b16 v[206:207], v239 offset:13568
s_waitcnt lgkmcnt(5)
v_mfma_f32_32x32x16_bf16 v[32:47], v[192:195], v[180:183], v[32:47]
ds_read_b64_tr_b16 v[208:209], v239 offset:12800
ds_read_b64_tr_b16 v[210:211], v239 offset:13824
ds_read_b128 v[188:191], v240 offset:512
v_mfma_f32_32x32x16_bf16 v[48:63], v[196:199], v[180:183], v[48:63]
ds_read_b64_tr_b16 v[212:213], v239 offset:13056
ds_read_b64_tr_b16 v[214:215], v239 offset:14080
s_waitcnt lgkmcnt(5)
v_mfma_f32_32x32x16_bf16 v[64:79], v[200:203], v[180:183], v[64:79]
v_cmp_ne_u32 vcc, 1, v238
s_nop 0
s_cbranch_vccnz L_spin3
L_back3:
v_add_u32 v241, 86016, v228
ds_read_b64_tr_b16 v[192:193], v241 offset:0
ds_read_b64_tr_b16 v[194:195], v241 offset:1024
v_mfma_f32_32x32x16_bf16 v[80:95], v[204:207], v[180:183], v[80:95]
ds_read_b64_tr_b16 v[196:197], v241 offset:256
ds_read_b64_tr_b16 v[198:199], v241 offset:1280
s_waitcnt lgkmcnt(4)
v_mfma_f32_32x32x16_bf16 v[96:111], v[208:211], v[180:183], v[96:111]
ds_read_b64_tr_b16 v[200:201], v241 offset:512
ds_read_b64_tr_b16 v[202:203], v241 offset:1536
v_mfma_f32_32x32x16_bf16 v[112:127], v[212:215], v[180:183], v[112:127]
global_load_lds_dword v235, s[96:97] offset:244
ds_read_b64_tr_b16 v[204:205], v241 offset:768
ds_read_b64_tr_b16 v[206:207], v241 offset:1792
s_waitcnt lgkmcnt(4)
v_mfma_f32_32x32x16_bf16 v[0:15], v[192:195], v[184:187], v[0:15]
ds_read_b64_tr_b16 v[208:209], v241 offset:8192
ds_read_b64_tr_b16 v[210:211], v241 offset:9216
v_mfma_f32_32x32x16_bf16 v[16:31], v[196:199], v[184:187], v[16:31]
ds_read_b64_tr_b16 v[212:213], v241 offset:8448
ds_read_b64_tr_b16 v[214:215], v241 offset:9472
s_waitcnt lgkmcnt(4)
v_mfma_f32_32x32x16_bf16 v[32:47], v[200:203], v[184:187], v[32:47]
ds_read_b64_tr_b16 v[192:193], v241 offset:8704
ds_read_b64_tr_b16 v[194:195], v241 offset:9728
v_mfma_f32_32x32x16_bf16 v[48:63], v[204:207], v[184:187], v[48:63]
ds_read_b64_tr_b16 v[196:197], v241 offset:8960
ds_read_b64_tr_b16 v[198:199], v241 offset:9984
s_waitcnt lgkmcnt(4)
v_mfma_f32_32x32x16_bf16 v[64:79], v[208:211], v[184:187], v[64:79]
ds_read_b64_tr_b16 v[200:201], v241 offset:4096
ds_read_b64_tr_b16 v[202:203], v241 offset:5120
v_mfma_f32_32x32x16_bf16 v[80:95], v[212:215], v[184:187], v[80:95]
ds_read_b64_tr_b16 v[204:205], v241 offset:4352
ds_read_b64_tr_b16 v[206:207], v241 offset:5376
s_waitcnt lgkmcnt(4)
v_mfma_f32_32x32x16_bf16 v[96:111], v[192:195], v[184:187], v[96:111]
ds_read_b64_tr_b16 v[208:209], v241 offset:4608
ds_read_b64_tr_b16 v[210:211], v241 offset:5632
v_mfma_f32_32x32x16_bf16 v[112:127], v[196:199], v[184:187], v[112:127]
ds_read_b64_tr_b16 v[212:213], v241 offset:4864
ds_read_b64_tr_b16 v[214:215], v241 offset:5888
s_waitcnt lgkmcnt(4)
v_mfma_f32_32x32x16_bf16 v[0:15], v[200:203], v[188:191], v[0:15]
ds_read_b64_tr_b16 v[192:193], v241 offset:12288
ds_read_b64_tr_b16 v[194:195], v241 offset:13312
v_mfma_f32_32x32x16_bf16 v[16:31], v[204:207], v[188:191], v[16:31]
ds_read_b32 v238, v236 offset:128
ds_read_b64_tr_b16 v[196:197], v241 offset:12544
ds_read_b64_tr_b16 v[198:199], v241 offset:13568
s_waitcnt lgkmcnt(5)
v_mfma_f32_32x32x16_bf16 v[32:47], v[208:211], v[188:191], v[32:47]
ds_read_b64_tr_b16 v[200:201], v241 offset:12800
ds_read_b64_tr_b16 v[202:203], v241 offset:13824
v_mfma_f32_32x32x16_bf16 v[48:63], v[212:215], v[188:191], v[48:63]
ds_read_b64_tr_b16 v[204:205], v241 offset:13056
ds_read_b64_tr_b16 v[206:207], v241 offset:14080
s_waitcnt lgkmcnt(4)
v_mfma_f32_32x32x16_bf16 v[64:79], v[192:195], v[188:191], v[64:79]
v_cmp_ne_u32 vcc, 1, v238
s_nop 0
s_cbranch_vccnz L_spin4
L_back4:
v_add_u32 v242, 102400, v230
ds_read_b128 v[160:163], v242 offset:0
v_add_u32 v243, 118784, v228
ds_read_b64_tr_b16 v[208:209], v243 offset:0
ds_read_b64_tr_b16 v[210:211], v243 offset:1024
v_mfma_f32_32x32x16_bf16 v[80:95], v[196:199], v[188:191], v[80:95]
ds_read_b64_tr_b16 v[212:213], v243 offset:256
ds_read_b64_tr_b16 v[214:215], v243 offset:1280
s_waitcnt lgkmcnt(5)
v_mfma_f32_32x32x16_bf16 v[96:111], v[200:203], v[188:191], v[96:111]
ds_read_b64_tr_b16 v[192:193], v243 offset:512
ds_read_b64_tr_b16 v[194:195], v243 offset:1536
v_mfma_f32_32x32x16_bf16 v[112:127], v[204:207], v[188:191], v[112:127]
global_load_lds_dword v235, s[96:97] offset:240
ds_read_b64_tr_b16 v[196:197], v243 offset:768
ds_read_b64_tr_b16 v[198:199], v243 offset:1792
s_waitcnt lgkmcnt(4)
v_mfma_f32_32x32x16_bf16 v[0:15], v[208:211], v[160:163], v[0:15]
ds_read_b64_tr_b16 v[200:201], v243 offset:8192
ds_read_b64_tr_b16 v[202:203], v243 offset:9216
v_mfma_f32_32x32x16_bf16 v[16:31], v[212:215], v[160:163], v[16:31]
ds_read_b64_tr_b16 v[204:205], v243 offset:8448
ds_read_b64_tr_b16 v[206:207], v243 offset:9472
s_waitcnt lgkmcnt(4)
v_mfma_f32_32x32x16_bf16 v[32:47], v[192:195], v[160:163], v[32:47]
ds_read_b64_tr_b16 v[208:209], v243 offset:8704
ds_read_b64_tr_b16 v[210:211], v243 offset:9728
ds_read_b128 v[168:171], v242 offset:512
v_mfma_f32_32x32x16_bf16 v[48:63], v[196:199], v[160:163], v[48:63]
ds_read_b64_tr_b16 v[212:213], v243 offset:8960
ds_read_b64_tr_b16 v[214:215], v243 offset:9984
s_waitcnt lgkmcnt(5)
v_mfma_f32_32x32x16_bf16 v[64:79], v[200:203], v[160:163], v[64:79]
v_add_u32 v239, 102400, v231
ds_read_b128 v[164:167], v239 offset:0
ds_read_b64_tr_b16 v[192:193], v243 offset:4096
ds_read_b64_tr_b16 v[194:195], v243 offset:5120
v_mfma_f32_32x32x16_bf16 v[80:95], v[204:207], v[160:163], v[80:95]
ds_read_b64_tr_b16 v[196:197], v243 offset:4352
ds_read_b64_tr_b16 v[198:199], v243 offset:5376
s_waitcnt lgkmcnt(5)
v_mfma_f32_32x32x16_bf16 v[96:111], v[208:211], v[160:163], v[96:111]
ds_read_b64_tr_b16 v[200:201], v243 offset:4608
ds_read_b64_tr_b16 v[202:203], v243 offset:5632
v_mfma_f32_32x32x16_bf16 v[112:127], v[212:215], v[160:163], v[112:127]
ds_read_b64_tr_b16 v[204:205], v243 offset:4864
ds_read_b64_tr_b16 v[206:207], v243 offset:5888
s_waitcnt lgkmcnt(4)
v_mfma_f32_32x32x16_bf16 v[0:15], v[192:195], v[164:167], v[0:15]
ds_read_b64_tr_b16 v[208:209], v243 offset:12288
ds_read_b64_tr_b16 v[210:211], v243 offset:13312
v_mfma_f32_32x32x16_bf16 v[16:31], v[196:199], v[164:167], v[16:31]
ds_read_b32 v238, v236 offset:160
ds_read_b64_tr_b16 v[212:213], v243 offset:12544
ds_read_b64_tr_b16 v[214:215], v243 offset:13568
s_waitcnt lgkmcnt(5)
v_mfma_f32_32x32x16_bf16 v[32:47], v[200:203], v[164:167], v[32:47]
ds_read_b64_tr_b16 v[192:193], v243 offset:12800
ds_read_b64_tr_b16 v[194:195], v243 offset:13824
ds_read_b128 v[172:175], v239 offset:512
v_mfma_f32_32x32x16_bf16 v[48:63], v[204:207], v[164:167], v[48:63]
ds_read_b64_tr_b16 v[196:197], v243 offset:13056
ds_read_b64_tr_b16 v[198:199], v243 offset:14080
s_waitcnt lgkmcnt(5)
v_mfma_f32_32x32x16_bf16 v[64:79], v[208:211], v[164:167], v[64:79]
v_cmp_ne_u32 vcc, 1, v238
s_nop 0
s_cbranch_vccnz L_spin5
L_back5:
v_add_u32 v240, 135168, v228
ds_read_b64_tr_b16 v[200:201], v240 offset:0
ds_read_b64_tr_b16 v[202:203], v240 offset:1024
v_mfma_f32_32x32x16_bf16 v[80:95], v[212:215], v[164:167], v[80:95]
ds_read_b64_tr_b16 v[204:205], v240 offset:256
ds_read_b64_tr_b16 v[206:207], v240 offset:1280
s_waitcnt lgkmcnt(4)
v_mfma_f32_32x32x16_bf16 v[96:111], v[192:195], v[164:167], v[96:111]
ds_read_b64_tr_b16 v[208:209], v240 offset:512
ds_read_b64_tr_b16 v[210:211], v240 offset:1536
v_mfma_f32_32x32x16_bf16 v[112:127], v[196:199], v[164:167], v[112:127]
global_load_lds_dword v235, s[96:97] offset:236
ds_read_b64_tr_b16 v[212:213], v240 offset:768
ds_read_b64_tr_b16 v[214:215], v240 offset:1792
s_waitcnt lgkmcnt(4)
v_mfma_f32_32x32x16_bf16 v[0:15], v[200:203], v[168:171], v[0:15]
ds_read_b64_tr_b16 v[192:193], v240 offset:8192
ds_read_b64_tr_b16 v[194:195], v240 offset:9216
v_mfma_f32_32x32x16_bf16 v[16:31], v[204:207], v[168:171], v[16:31]
ds_read_b64_tr_b16 v[196:197], v240 offset:8448
ds_read_b64_tr_b16 v[198:199], v240 offset:9472
s_waitcnt lgkmcnt(4)
v_mfma_f32_32x32x16_bf16 v[32:47], v[208:211], v[168:171], v[32:47]
ds_read_b64_tr_b16 v[200:201], v240 offset:8704
ds_read_b64_tr_b16 v[202:203], v240 offset:9728
v_mfma_f32_32x32x16_bf16 v[48:63], v[212:215], v[168:171], v[48:63]
ds_read_b64_tr_b16 v[204:205], v240 offset:8960
ds_read_b64_tr_b16 v[206:207], v240 offset:9984
s_waitcnt lgkmcnt(4)
v_mfma_f32_32x32x16_bf16 v[64:79], v[192:195], v[168:171], v[64:79]
ds_read_b64_tr_b16 v[208:209], v240 offset:4096
ds_read_b64_tr_b16 v[210:211], v240 offset:5120
v_mfma_f32_32x32x16_bf16 v[80:95], v[196:199], v[168:171], v[80:95]
ds_read_b64_tr_b16 v[212:213], v240 offset:4352
ds_read_b64_tr_b16 v[214:215], v240 offset:5376
s_waitcnt lgkmcnt(4)
v_mfma_f32_32x32x16_bf16 v[96:111], v[200:203], v[168:171], v[96:111]
ds_read_b64_tr_b16 v[192:193], v240 offset:4608
ds_read_b64_tr_b16 v[194:195], v240 offset:5632
v_mfma_f32_32x32x16_bf16 v[112:127], v[204:207], v[168:171], v[112:127]
ds_read_b64_tr_b16 v[196:197], v240 offset:4864
ds_read_b64_tr_b16 v[198:199], v240 offset:5888
s_waitcnt lgkmcnt(4)
v_mfma_f32_32x32x16_bf16 v[0:15], v[208:211], v[172:175], v[0:15]
ds_read_b64_tr_b16 v[200:201], v240 offset:12288
ds_read_b64_tr_b16 v[202:203], v240 offset:13312
v_mfma_f32_32x32x16_bf16 v[16:31], v[212:215], v[172:175], v[16:31]
ds_read_b32 v238, v236 offset:192
ds_read_b64_tr_b16 v[204:205], v240 offset:12544
ds_read_b64_tr_b16 v[206:207], v240 offset:13568
s_waitcnt lgkmcnt(5)
v_mfma_f32_32x32x16_bf16 v[32:47], v[192:195], v[172:175], v[32:47]
ds_read_b64_tr_b16 v[208:209], v240 offset:12800
ds_read_b64_tr_b16 v[210:211], v240 offset:13824
v_mfma_f32_32x32x16_bf16 v[48:63], v[196:199], v[172:175], v[48:63]
ds_read_b64_tr_b16 v[212:213], v240 offset:13056
ds_read_b64_tr_b16 v[214:215], v240 offset:14080
s_waitcnt lgkmcnt(4)
v_mfma_f32_32x32x16_bf16 v[64:79], v[200:203], v[172:175], v[64:79]
v_cmp_ne_u32 vcc, 1, v238
s_nop 0
s_cbranch_vccnz L_spin6
L_back6:
v_add_u32 v241, 4096, v230
ds_read_b128 v[176:179], v241 offset:0
v_add_u32 v242, 20480, v228
ds_read_b64_tr_b16 v[192:193], v242 offset:0
ds_read_b64_tr_b16 v[194:195], v242 offset:1024
v_mfma_f32_32x32x16_bf16 v[80:95], v[204:207], v[172:175], v[80:95]
ds_read_b64_tr_b16 v[196:197], v242 offset:256
ds_read_b64_tr_b16 v[198:199], v242 offset:1280
s_cmp_lg_u32 s54, 0
s_cbranch_scc0 L_lead
L_leadret:
s_waitcnt lgkmcnt(5)
v_mfma_f32_32x32x16_bf16 v[96:111], v[208:211], v[172:175], v[96:111]
ds_read_b64_tr_b16 v[200:201], v242 offset:512
ds_read_b64_tr_b16 v[202:203], v242 offset:1536
v_mfma_f32_32x32x16_bf16 v[112:127], v[212:215], v[172:175], v[112:127]
global_load_lds_dword v235, s[96:97] offset:232
ds_read_b64_tr_b16 v[204:205], v242 offset:768
ds_read_b64_tr_b16 v[206:207], v242 offset:1792
s_waitcnt lgkmcnt(4)
v_mfma_f32_32x32x16_bf16 v[0:15], v[192:195], v[176:179], v[0:15]
ds_read_b64_tr_b16 v[208:209], v242 offset:8192
ds_read_b64_tr_b16 v[210:211], v242 offset:9216
v_mfma_f32_32x32x16_bf16 v[16:31], v[196:199], v[176:179], v[16:31]
ds_read_b64_tr_b16 v[212:213], v242 offset:8448
ds_read_b64_tr_b16 v[214:215], v242 offset:9472
s_waitcnt lgkmcnt(4)
v_mfma_f32_32x32x16_bf16 v[32:47], v[200:203], v[176:179], v[32:47]
ds_read_b64_tr_b16 v[192:193], v242 offset:8704
ds_read_b64_tr_b16 v[194:195], v242 offset:9728
ds_read_b128 v[184:187], v241 offset:512
v_mfma_f32_32x32x16_bf16 v[48:63], v[204:207], v[176:179], v[48:63]
ds_read_b64_tr_b16 v[196:197], v242 offset:8960
ds_read_b64_tr_b16 v[198:199], v242 offset:9984
s_waitcnt lgkmcnt(5)
v_mfma_f32_32x32x16_bf16 v[64:79], v[208:211], v[176:179], v[64:79]
v_add_u32 v243, 4096, v231
ds_read_b128 v[180:183], v243 offset:0
ds_read_b64_tr_b16 v[200:201], v242 offset:4096
ds_read_b64_tr_b16 v[202:203], v242 offset:5120
v_mfma_f32_32x32x16_bf16 v[80:95], v[212:215], v[176:179], v[80:95]
ds_read_b64_tr_b16 v[204:205], v242 offset:4352
ds_read_b64_tr_b16 v[206:207], v242 offset:5376
s_waitcnt lgkmcnt(5)
v_mfma_f32_32x32x16_bf16 v[96:111], v[192:195], v[176:179], v[96:111]
ds_read_b64_tr_b16 v[208:209], v242 offset:4608
ds_read_b64_tr_b16 v[210:211], v242 offset:5632
v_mfma_f32_32x32x16_bf16 v[112:127], v[196:199], v[176:179], v[112:127]
ds_read_b64_tr_b16 v[212:213], v242 offset:4864
ds_read_b64_tr_b16 v[214:215], v242 offset:5888
s_waitcnt lgkmcnt(4)
v_mfma_f32_32x32x16_bf16 v[0:15], v[200:203], v[180:183], v[0:15]
ds_read_b64_tr_b16 v[192:193], v242 offset:12288
ds_read_b64_tr_b16 v[194:195], v242 offset:13312
v_mfma_f32_32x32x16_bf16 v[16:31], v[204:207], v[180:183], v[16:31]
ds_read_b32 v238, v236 offset:224
ds_read_b64_tr_b16 v[196:197], v242 offset:12544
ds_read_b64_tr_b16 v[198:199], v242 offset:13568
s_waitcnt lgkmcnt(5)
v_mfma_f32_32x32x16_bf16 v[32:47], v[208:211], v[180:183], v[32:47]
ds_read_b64_tr_b16 v[200:201], v242 offset:12800
ds_read_b64_tr_b16 v[202:203], v242 offset:13824
ds_read_b128 v[188:191], v243 offset:512
v_mfma_f32_32x32x16_bf16 v[48:63], v[212:215], v[180:183], v[48:63]
ds_read_b64_tr_b16 v[204:205], v242 offset:13056
ds_read_b64_tr_b16 v[206:207], v242 offset:14080
s_waitcnt lgkmcnt(5)
v_mfma_f32_32x32x16_bf16 v[64:79], v[192:195], v[180:183], v[64:79]
v_cmp_ne_u32 vcc, 1, v238
s_nop 0
s_cbranch_vccnz L_spin7
L_back7:
v_add_u32 v239, 36864, v228
ds_read_b64_tr_b16 v[208:209], v239 offset:0
ds_read_b64_tr_b16 v[210:211], v239 offset:1024
v_mfma_f32_32x32x16_bf16 v[80:95], v[196:199], v[180:183], v[80:95]
ds_read_b64_tr_b16 v[212:213], v239 offset:256
ds_read_b64_tr_b16 v[214:215], v239 offset:1280
s_waitcnt lgkmcnt(4)
v_mfma_f32_32x32x16_bf16 v[96:111], v[200:203], v[180:183], v[96:111]
ds_read_b64_tr_b16 v[192:193], v239 offset:512
ds_read_b64_tr_b16 v[194:195], v239 offset:1536
v_mfma_f32_32x32x16_bf16 v[112:127], v[204:207], v[180:183], v[112:127]
global_load_lds_dword v235, s[96:97] offset:228
ds_read_b64_tr_b16 v[196:197], v239 offset:768
ds_read_b64_tr_b16 v[198:199], v239 offset:1792
s_waitcnt lgkmcnt(4)
v_mfma_f32_32x32x16_bf16 v[0:15], v[208:211], v[184:187], v[0:15]
ds_read_b64_tr_b16 v[200:201], v239 offset:8192
ds_read_b64_tr_b16 v[202:203], v239 offset:9216
v_mfma_f32_32x32x16_bf16 v[16:31], v[212:215], v[184:187], v[16:31]
ds_read_b64_tr_b16 v[204:205], v239 offset:8448
ds_read_b64_tr_b16 v[206:207], v239 offset:9472
s_waitcnt lgkmcnt(4)
v_mfma_f32_32x32x16_bf16 v[32:47], v[192:195], v[184:187], v[32:47]
ds_read_b64_tr_b16 v[208:209], v239 offset:8704
ds_read_b64_tr_b16 v[210:211], v239 offset:9728
v_mfma_f32_32x32x16_bf16 v[48:63], v[196:199], v[184:187], v[48:63]
ds_read_b64_tr_b16 v[212:213], v239 offset:8960
ds_read_b64_tr_b16 v[214:215], v239 offset:9984
s_waitcnt lgkmcnt(4)
v_mfma_f32_32x32x16_bf16 v[64:79], v[200:203], v[184:187], v[64:79]
ds_read_b64_tr_b16 v[192:193], v239 offset:4096
ds_read_b64_tr_b16 v[194:195], v239 offset:5120
v_mfma_f32_32x32x16_bf16 v[80:95], v[204:207], v[184:187], v[80:95]
ds_read_b64_tr_b16 v[196:197], v239 offset:4352
ds_read_b64_tr_b16 v[198:199], v239 offset:5376
s_waitcnt lgkmcnt(4)
v_mfma_f32_32x32x16_bf16 v[96:111], v[208:211], v[184:187], v[96:111]
ds_read_b64_tr_b16 v[200:201], v239 offset:4608
ds_read_b64_tr_b16 v[202:203], v239 offset:5632
v_mfma_f32_32x32x16_bf16 v[112:127], v[212:215], v[184:187], v[112:127]
ds_read_b64_tr_b16 v[204:205], v239 offset:4864
ds_read_b64_tr_b16 v[206:207], v239 offset:5888
s_waitcnt lgkmcnt(4)
v_mfma_f32_32x32x16_bf16 v[0:15], v[192:195], v[188:191], v[0:15]
ds_read_b64_tr_b16 v[208:209], v239 offset:12288
ds_read_b64_tr_b16 v[210:211], v239 offset:13312
v_mfma_f32_32x32x16_bf16 v[16:31], v[196:199], v[188:191], v[16:31]
ds_read_b32 v238, v236 offset:256
ds_read_b64_tr_b16 v[212:213], v239 offset:12544
ds_read_b64_tr_b16 v[214:215], v239 offset:13568
s_waitcnt lgkmcnt(5)
v_mfma_f32_32x32x16_bf16 v[32:47], v[200:203], v[188:191], v[32:47]
ds_read_b64_tr_b16 v[192:193], v239 offset:12800
ds_read_b64_tr_b16 v[194:195], v239 offset:13824
v_mfma_f32_32x32x16_bf16 v[48:63], v[204:207], v[188:191], v[48:63]
ds_read_b64_tr_b16 v[196:197], v239 offset:13056
ds_read_b64_tr_b16 v[198:199], v239 offset:14080
s_waitcnt lgkmcnt(4)
v_mfma_f32_32x32x16_bf16 v[64:79], v[208:211], v[188:191], v[64:79]
v_cmp_ne_u32 vcc, 1, v238
s_nop 0
s_cbranch_vccnz L_spin8
L_back8:
v_add_u32 v240, 53248, v230
ds_read_b128 v[160:163], v240 offset:0
v_add_u32 v241, 69632, v228
ds_read_b64_tr_b16 v[200:201], v241 offset:0
ds_read_b64_tr_b16 v[202:203], v241 offset:1024
v_mfma_f32_32x32x16_bf16 v[80:95], v[212:215], v[188:191], v[80:95]
ds_read_b64_tr_b16 v[204:205], v241 offset:256
ds_read_b64_tr_b16 v[206:207], v241 offset:1280
s_waitcnt lgkmcnt(5)
v_mfma_f32_32x32x16_bf16 v[96:111], v[192:195], v[188:191], v[96:111]
ds_read_b64_tr_b16 v[208:209], v241 offset:512
ds_read_b64_tr_b16 v[210:211], v241 offset:1536
v_mfma_f32_32x32x16_bf16 v[112:127], v[196:199], v[188:191], v[112:127]
global_load_lds_dword v235, s[96:97] offset:224
ds_read_b64_tr_b16 v[212:213], v241 offset:768
ds_read_b64_tr_b16 v[214:215], v241 offset:1792
s_waitcnt lgkmcnt(4)
v_mfma_f32_32x32x16_bf16 v[0:15], v[200:203], v[160:163], v[0:15]
ds_read_b64_tr_b16 v[192:193], v241 offset:8192
ds_read_b64_tr_b16 v[194:195], v241 offset:9216
v_mfma_f32_32x32x16_bf16 v[16:31], v[204:207], v[160:163], v[16:31]
ds_read_b64_tr_b16 v[196:197], v241 offset:8448
ds_read_b64_tr_b16 v[198:199], v241 offset:9472
s_waitcnt lgkmcnt(4)
v_mfma_f32_32x32x16_bf16 v[32:47], v[208:211], v[160:163], v[32:47]
ds_read_b64_tr_b16 v[200:201], v241 offset:8704
ds_read_b64_tr_b16 v[202:203], v241 offset:9728
ds_read_b128 v[168:171], v240 offset:512
v_mfma_f32_32x32x16_bf16 v[48:63], v[212:215], v[160:163], v[48:63]
ds_read_b64_tr_b16 v[204:205], v241 offset:8960
ds_read_b64_tr_b16 v[206:207], v241 offset:9984
s_waitcnt lgkmcnt(5)
v_mfma_f32_32x32x16_bf16 v[64:79], v[192:195], v[160:163], v[64:79]
v_add_u32 v242, 53248, v231
ds_read_b128 v[164:167], v242 offset:0
ds_read_b64_tr_b16 v[208:209], v241 offset:4096
ds_read_b64_tr_b16 v[210:211], v241 offset:5120
v_mfma_f32_32x32x16_bf16 v[80:95], v[196:199], v[160:163], v[80:95]
ds_read_b64_tr_b16 v[212:213], v241 offset:4352
ds_read_b64_tr_b16 v[214:215], v241 offset:5376
s_waitcnt lgkmcnt(5)
v_mfma_f32_32x32x16_bf16 v[96:111], v[200:203], v[160:163], v[96:111]
ds_read_b64_tr_b16 v[192:193], v241 offset:4608
ds_read_b64_tr_b16 v[194:195], v241 offset:5632
v_mfma_f32_32x32x16_bf16 v[112:127], v[204:207], v[160:163], v[112:127]
ds_read_b64_tr_b16 v[196:197], v241 offset:4864
ds_read_b64_tr_b16 v[198:199], v241 offset:5888
s_waitcnt lgkmcnt(4)
v_mfma_f32_32x32x16_bf16 v[0:15], v[208:211], v[164:167], v[0:15]
ds_read_b64_tr_b16 v[200:201], v241 offset:12288
ds_read_b64_tr_b16 v[202:203], v241 offset:13312
v_mfma_f32_32x32x16_bf16 v[16:31], v[212:215], v[164:167], v[16:31]
ds_read_b32 v238, v236 offset:288
ds_read_b64_tr_b16 v[204:205], v241 offset:12544
ds_read_b64_tr_b16 v[206:207], v241 offset:13568
s_waitcnt lgkmcnt(5)
v_mfma_f32_32x32x16_bf16 v[32:47], v[192:195], v[164:167], v[32:47]
ds_read_b64_tr_b16 v[208:209], v241 offset:12800
ds_read_b64_tr_b16 v[210:211], v241 offset:13824
ds_read_b128 v[172:175], v242 offset:512
v_mfma_f32_32x32x16_bf16 v[48:63], v[196:199], v[164:167], v[48:63]
ds_read_b64_tr_b16 v[212:213], v241 offset:13056
ds_read_b64_tr_b16 v[214:215], v241 offset:14080
s_waitcnt lgkmcnt(5)
v_mfma_f32_32x32x16_bf16 v[64:79], v[200:203], v[164:167], v[64:79]
v_cmp_ne_u32 vcc, 1, v238
s_nop 0
s_cbranch_vccnz L_spin9
L_back9:
v_add_u32 v243, 86016, v228
ds_read_b64_tr_b16 v[192:193], v243 offset:0
ds_read_b64_tr_b16 v[194:195], v243 offset:1024
v_mfma_f32_32x32x16_bf16 v[80:95], v[204:207], v[164:167], v[80:95]
ds_read_b64_tr_b16 v[196:197], v243 offset:256
ds_read_b64_tr_b16 v[198:199], v243 offset:1280
s_waitcnt lgkmcnt(4)
v_mfma_f32_32x32x16_bf16 v[96:111], v[208:211], v[164:167], v[96:111]
ds_read_b64_tr_b16 v[200:201], v243 offset:512
ds_read_b64_tr_b16 v[202:203], v243 offset:1536
v_mfma_f32_32x32x16_bf16 v[112:127], v[212:215], v[164:167], v[112:127]
global_load_lds_dword v235, s[96:97] offset:220
ds_read_b64_tr_b16 v[204:205], v243 offset:768
ds_read_b64_tr_b16 v[206:207], v243 offset:1792
s_waitcnt lgkmcnt(4)
v_mfma_f32_32x32x16_bf16 v[0:15], v[192:195], v[168:171], v[0:15]
ds_read_b64_tr_b16 v[208:209], v243 offset:8192
ds_read_b64_tr_b16 v[210:211], v243 offset:9216
v_mfma_f32_32x32x16_bf16 v[16:31], v[196:199], v[168:171], v[16:31]
ds_read_b64_tr_b16 v[212:213], v243 offset:8448
ds_read_b64_tr_b16 v[214:215], v243 offset:9472
s_waitcnt lgkmcnt(4)
v_mfma_f32_32x32x16_bf16 v[32:47], v[200:203], v[168:171], v[32:47]
ds_read_b64_tr_b16 v[192:193], v243 offset:8704
ds_read_b64_tr_b16 v[194:195], v243 offset:9728
v_mfma_f32_32x32x16_bf16 v[48:63], v[204:207], v[168:171], v[48:63]
ds_read_b64_tr_b16 v[196:197], v243 offset:8960
ds_read_b64_tr_b16 v[198:199], v243 offset:9984
s_waitcnt lgkmcnt(4)
v_mfma_f32_32x32x16_bf16 v[64:79], v[208:211], v[168:171], v[64:79]
ds_read_b64_tr_b16 v[200:201], v243 offset:4096
ds_read_b64_tr_b16 v[202:203], v243 offset:5120
v_mfma_f32_32x32x16_bf16 v[80:95], v[212:215], v[168:171], v[80:95]
ds_read_b64_tr_b16 v[204:205], v243 offset:4352
ds_read_b64_tr_b16 v[206:207], v243 offset:5376
s_waitcnt lgkmcnt(4)
v_mfma_f32_32x32x16_bf16 v[96:111], v[192:195], v[168:171], v[96:111]
ds_read_b64_tr_b16 v[208:209], v243 offset:4608
ds_read_b64_tr_b16 v[210:211], v243 offset:5632
v_mfma_f32_32x32x16_bf16 v[112:127], v[196:199], v[168:171], v[112:127]
ds_read_b64_tr_b16 v[212:213], v243 offset:4864
ds_read_b64_tr_b16 v[214:215], v243 offset:5888
s_waitcnt lgkmcnt(4)
v_mfma_f32_32x32x16_bf16 v[0:15], v[200:203], v[172:175], v[0:15]
ds_read_b64_tr_b16 v[192:193], v243 offset:12288
ds_read_b64_tr_b16 v[194:195], v243 offset:13312
v_mfma_f32_32x32x16_bf16 v[16:31], v[204:207], v[172:175], v[16:31]
ds_read_b32 v238, v236 offset:320
ds_read_b64_tr_b16 v[196:197], v243 offset:12544
ds_read_b64_tr_b16 v[198:199], v243 offset:13568
s_waitcnt lgkmcnt(5)
v_mfma_f32_32x32x16_bf16 v[32:47], v[208:211], v[172:175], v[32:47]
ds_read_b64_tr_b16 v[200:201], v243 offset:12800
ds_read_b64_tr_b16 v[202:203], v243 offset:13824
v_mfma_f32_32x32x16_bf16 v[48:63], v[212:215], v[172:175], v[48:63]
ds_read_b64_tr_b16 v[204:205], v243 offset:13056
ds_read_b64_tr_b16 v[206:207], v243 offset:14080
s_waitcnt lgkmcnt(4)
v_mfma_f32_32x32x16_bf16 v[64:79], v[192:195], v[172:175], v[64:79]
v_cmp_ne_u32 vcc, 1, v238
s_nop 0
s_cbranch_vccnz L_spin10
L_back10:
v_add_u32 v239, 102400, v230
ds_read_b128 v[176:179], v239 offset:0
v_add_u32 v240, 118784, v228
ds_read_b64_tr_b16 v[208:209], v240 offset:0
ds_read_b64_tr_b16 v[210:211], v240 offset:1024
v_mfma_f32_32x32x16_bf16 v[80:95], v[196:199], v[172:175], v[80:95]
ds_read_b64_tr_b16 v[212:213], v240 offset:256
ds_read_b64_tr_b16 v[214:215], v240 offset:1280
s_waitcnt lgkmcnt(5)
v_mfma_f32_32x32x16_bf16 v[96:111], v[200:203], v[172:175], v[96:111]
ds_read_b64_tr_b16 v[192:193], v240 offset:512
ds_read_b64_tr_b16 v[194:195], v240 offset:1536
v_mfma_f32_32x32x16_bf16 v[112:127], v[204:207], v[172:175], v[112:127]
global_load_lds_dword v235, s[96:97] offset:216
ds_read_b64_tr_b16 v[196:197], v240 offset:768
ds_read_b64_tr_b16 v[198:199], v240 offset:1792
s_waitcnt lgkmcnt(4)
v_mfma_f32_32x32x16_bf16 v[0:15], v[208:211], v[176:179], v[0:15]
ds_read_b64_tr_b16 v[200:201], v240 offset:8192
ds_read_b64_tr_b16 v[202:203], v240 offset:9216
v_mfma_f32_32x32x16_bf16 v[16:31], v[212:215], v[176:179], v[16:31]
ds_read_b64_tr_b16 v[204:205], v240 offset:8448
ds_read_b64_tr_b16 v[206:207], v240 offset:9472
s_waitcnt lgkmcnt(4)
v_mfma_f32_32x32x16_bf16 v[32:47], v[192:195], v[176:179], v[32:47]
ds_read_b64_tr_b16 v[208:209], v240 offset:8704
ds_read_b64_tr_b16 v[210:211], v240 offset:9728
ds_read_b128 v[184:187], v239 offset:512
v_mfma_f32_32x32x16_bf16 v[48:63], v[196:199], v[176:179], v[48:63]
ds_read_b64_tr_b16 v[212:213], v240 offset:8960
ds_read_b64_tr_b16 v[214:215], v240 offset:9984
s_waitcnt lgkmcnt(5)
v_mfma_f32_32x32x16_bf16 v[64:79], v[200:203], v[176:179], v[64:79]
v_add_u32 v241, 102400, v231
ds_read_b128 v[180:183], v241 offset:0
ds_read_b64_tr_b16 v[192:193], v240 offset:4096
ds_read_b64_tr_b16 v[194:195], v240 offset:5120
v_mfma_f32_32x32x16_bf16 v[80:95], v[204:207], v[176:179], v[80:95]
ds_read_b64_tr_b16 v[196:197], v240 offset:4352
ds_read_b64_tr_b16 v[198:199], v240 offset:5376
s_waitcnt lgkmcnt(5)
v_mfma_f32_32x32x16_bf16 v[96:111], v[208:211], v[176:179], v[96:111]
ds_read_b64_tr_b16 v[200:201], v240 offset:4608
ds_read_b64_tr_b16 v[202:203], v240 offset:5632
v_mfma_f32_32x32x16_bf16 v[112:127], v[212:215], v[176:179], v[112:127]
ds_read_b64_tr_b16 v[204:205], v240 offset:4864
ds_read_b64_tr_b16 v[206:207], v240 offset:5888
s_waitcnt lgkmcnt(4)
v_mfma_f32_32x32x16_bf16 v[0:15], v[192:195], v[180:183], v[0:15]
ds_read_b64_tr_b16 v[208:209], v240 offset:12288
ds_read_b64_tr_b16 v[210:211], v240 offset:13312
v_mfma_f32_32x32x16_bf16 v[16:31], v[196:199], v[180:183], v[16:31]
ds_read_b32 v238, v236 offset:352
ds_read_b64_tr_b16 v[212:213], v240 offset:12544
ds_read_b64_tr_b16 v[214:215], v240 offset:13568
s_waitcnt lgkmcnt(5)
v_mfma_f32_32x32x16_bf16 v[32:47], v[200:203], v[180:183], v[32:47]
ds_read_b64_tr_b16 v[192:193], v240 offset:12800
ds_read_b64_tr_b16 v[194:195], v240 offset:13824
ds_read_b128 v[188:191], v241 offset:512
v_mfma_f32_32x32x16_bf16 v[48:63], v[204:207], v[180:183], v[48:63]
ds_read_b64_tr_b16 v[196:197], v240 offset:13056
ds_read_b64_tr_b16 v[198:199], v240 offset:14080
s_waitcnt lgkmcnt(5)
v_mfma_f32_32x32x16_bf16 v[64:79], v[208:211], v[180:183], v[64:79]
v_cmp_ne_u32 vcc, 1, v238
s_nop 0
s_cbranch_vccnz L_spin11
L_back11:
v_add_u32 v242, 135168, v228
ds_read_b64_tr_b16 v[200:201], v242 offset:0
ds_read_b64_tr_b16 v[202:203], v242 offset:1024
v_mfma_f32_32x32x16_bf16 v[80:95], v[212:215], v[180:183], v[80:95]
ds_read_b64_tr_b16 v[204:205], v242 offset:256
ds_read_b64_tr_b16 v[206:207], v242 offset:1280
s_waitcnt lgkmcnt(4)
v_mfma_f32_32x32x16_bf16 v[96:111], v[192:195], v[180:183], v[96:111]
ds_read_b64_tr_b16 v[208:209], v242 offset:512
ds_read_b64_tr_b16 v[210:211], v242 offset:1536
v_mfma_f32_32x32x16_bf16 v[112:127], v[196:199], v[180:183], v[112:127]
global_load_lds_dword v235, s[96:97] offset:212
ds_read_b64_tr_b16 v[212:213], v242 offset:768
ds_read_b64_tr_b16 v[214:215], v242 offset:1792
s_waitcnt lgkmcnt(4)
v_mfma_f32_32x32x16_bf16 v[0:15], v[200:203], v[184:187], v[0:15]
ds_read_b64_tr_b16 v[192:193], v242 offset:8192
ds_read_b64_tr_b16 v[194:195], v242 offset:9216
v_mfma_f32_32x32x16_bf16 v[16:31], v[204:207], v[184:187], v[16:31]
ds_read_b64_tr_b16 v[196:197], v242 offset:8448
ds_read_b64_tr_b16 v[198:199], v242 offset:9472
s_waitcnt lgkmcnt(4)
v_mfma_f32_32x32x16_bf16 v[32:47], v[208:211], v[184:187], v[32:47]
ds_read_b64_tr_b16 v[200:201], v242 offset:8704
ds_read_b64_tr_b16 v[202:203], v242 offset:9728
v_mfma_f32_32x32x16_bf16 v[48:63], v[212:215], v[184:187], v[48:63]
ds_read_b64_tr_b16 v[204:205], v242 offset:8960
ds_read_b64_tr_b16 v[206:207], v242 offset:9984
s_waitcnt lgkmcnt(4)
v_mfma_f32_32x32x16_bf16 v[64:79], v[192:195], v[184:187], v[64:79]
ds_read_b64_tr_b16 v[208:209], v242 offset:4096
ds_read_b64_tr_b16 v[210:211], v242 offset:5120
v_mfma_f32_32x32x16_bf16 v[80:95], v[196:199], v[184:187], v[80:95]
ds_read_b64_tr_b16 v[212:213], v242 offset:4352
ds_read_b64_tr_b16 v[214:215], v242 offset:5376
s_waitcnt lgkmcnt(4)
v_mfma_f32_32x32x16_bf16 v[96:111], v[200:203], v[184:187], v[96:111]
ds_read_b64_tr_b16 v[192:193], v242 offset:4608
ds_read_b64_tr_b16 v[194:195], v242 offset:5632
v_mfma_f32_32x32x16_bf16 v[112:127], v[204:207], v[184:187], v[112:127]
ds_read_b64_tr_b16 v[196:197], v242 offset:4864
ds_read_b64_tr_b16 v[198:199], v242 offset:5888
s_waitcnt lgkmcnt(4)
v_mfma_f32_32x32x16_bf16 v[0:15], v[208:211], v[188:191], v[0:15]
ds_read_b64_tr_b16 v[200:201], v242 offset:12288
ds_read_b64_tr_b16 v[202:203], v242 offset:13312
v_mfma_f32_32x32x16_bf16 v[16:31], v[212:215], v[188:191], v[16:31]
ds_read_b32 v238, v236 offset:384
ds_read_b64_tr_b16 v[204:205], v242 offset:12544
ds_read_b64_tr_b16 v[206:207], v242 offset:13568
s_waitcnt lgkmcnt(5)
v_mfma_f32_32x32x16_bf16 v[32:47], v[192:195], v[188:191], v[32:47]
ds_read_b64_tr_b16 v[208:209], v242 offset:12800
ds_read_b64_tr_b16 v[210:211], v242 offset:13824
v_mfma_f32_32x32x16_bf16 v[48:63], v[196:199], v[188:191], v[48:63]
ds_read_b64_tr_b16 v[212:213], v242 offset:13056
ds_read_b64_tr_b16 v[214:215], v242 offset:14080
s_waitcnt lgkmcnt(4)
v_mfma_f32_32x32x16_bf16 v[64:79], v[200:203], v[188:191], v[64:79]
v_cmp_ne_u32 vcc, 1, v238
s_nop 0
s_cbranch_vccnz L_spin12
L_back12:
v_add_u32 v243, 4096, v230
ds_read_b128 v[160:163], v243 offset:0
v_add_u32 v239, 20480, v228
ds_read_b64_tr_b16 v[192:193], v239 offset:0
ds_read_b64_tr_b16 v[194:195], v239 offset:1024
v_mfma_f32_32x32x16_bf16 v[80:95], v[204:207], v[188:191], v[80:95]
ds_read_b64_tr_b16 v[196:197], v239 offset:256
ds_read_b64_tr_b16 v[198:199], v239 offset:1280
s_waitcnt lgkmcnt(5)
v_mfma_f32_32x32x16_bf16 v[96:111], v[208:211], v[188:191], v[96:111]
ds_read_b64_tr_b16 v[200:201], v239 offset:512
ds_read_b64_tr_b16 v[202:203], v239 offset:1536
v_mfma_f32_32x32x16_bf16 v[112:127], v[212:215], v[188:191], v[112:127]
global_load_lds_dword v235, s[96:97] offset:208
ds_read_b64_tr_b16 v[204:205], v239 offset:768
ds_read_b64_tr_b16 v[206:207], v239 offset:1792
s_waitcnt lgkmcnt(4)
v_mfma_f32_32x32x16_bf16 v[0:15], v[192:195], v[160:163], v[0:15]
ds_read_b64_tr_b16 v[208:209], v239 offset:8192
ds_read_b64_tr_b16 v[210:211], v239 offset:9216
v_mfma_f32_32x32x16_bf16 v[16:31], v[196:199], v[160:163], v[16:31]
ds_read_b64_tr_b16 v[212:213], v239 offset:8448
ds_read_b64_tr_b16 v[214:215], v239 offset:9472
s_waitcnt lgkmcnt(4)
v_mfma_f32_32x32x16_bf16 v[32:47], v[200:203], v[160:163], v[32:47]
ds_read_b64_tr_b16 v[192:193], v239 offset:8704
ds_read_b64_tr_b16 v[194:195], v239 offset:9728
ds_read_b128 v[168:171], v243 offset:512
v_mfma_f32_32x32x16_bf16 v[48:63], v[204:207], v[160:163], v[48:63]
ds_read_b64_tr_b16 v[196:197], v239 offset:8960
ds_read_b64_tr_b16 v[198:199], v239 offset:9984
s_waitcnt lgkmcnt(5)
v_mfma_f32_32x32x16_bf16 v[64:79], v[208:211], v[160:163], v[64:79]
v_add_u32 v240, 4096, v231
ds_read_b128 v[164:167], v240 offset:0
ds_read_b64_tr_b16 v[200:201], v239 offset:4096
ds_read_b64_tr_b16 v[202:203], v239 offset:5120
v_mfma_f32_32x32x16_bf16 v[80:95], v[212:215], v[160:163], v[80:95]
ds_read_b64_tr_b16 v[204:205], v239 offset:4352
ds_read_b64_tr_b16 v[206:207], v239 offset:5376
s_waitcnt lgkmcnt(5)
v_mfma_f32_32x32x16_bf16 v[96:111], v[192:195], v[160:163], v[96:111]
ds_read_b64_tr_b16 v[208:209], v239 offset:4608
ds_read_b64_tr_b16 v[210:211], v239 offset:5632
v_mfma_f32_32x32x16_bf16 v[112:127], v[196:199], v[160:163], v[112:127]
ds_read_b64_tr_b16 v[212:213], v239 offset:4864
ds_read_b64_tr_b16 v[214:215], v239 offset:5888
s_waitcnt lgkmcnt(4)
v_mfma_f32_32x32x16_bf16 v[0:15], v[200:203], v[164:167], v[0:15]
ds_read_b64_tr_b16 v[192:193], v239 offset:12288
ds_read_b64_tr_b16 v[194:195], v239 offset:13312
v_mfma_f32_32x32x16_bf16 v[16:31], v[204:207], v[164:167], v[16:31]
ds_read_b32 v238, v236 offset:416
ds_read_b64_tr_b16 v[196:197], v239 offset:12544
ds_read_b64_tr_b16 v[198:199], v239 offset:13568
s_waitcnt lgkmcnt(5)
v_mfma_f32_32x32x16_bf16 v[32:47], v[208:211], v[164:167], v[32:47]
ds_read_b64_tr_b16 v[200:201], v239 offset:12800
ds_read_b64_tr_b16 v[202:203], v239 offset:13824
ds_read_b128 v[172:175], v240 offset:512
buffer_load_dword v253, v235, s[40:43], s59 offen sc1
v_mfma_f32_32x32x16_bf16 v[48:63], v[212:215], v[164:167], v[48:63]
ds_read_b64_tr_b16 v[204:205], v239 offset:13056
ds_read_b64_tr_b16 v[206:207], v239 offset:14080
s_waitcnt lgkmcnt(5)
v_mfma_f32_32x32x16_bf16 v[64:79], v[192:195], v[164:167], v[64:79]
v_cmp_ne_u32 vcc, 1, v238
s_nop 0
s_cbranch_vccnz L_spin13
L_back13:
v_add_u32 v241, 69632, v228
ds_read_b64_tr_b16 v[208:209], v241 offset:0
ds_read_b64_tr_b16 v[210:211], v241 offset:1024
v_mfma_f32_32x32x16_bf16 v[80:95], v[196:199], v[164:167], v[80:95]
ds_read_b64_tr_b16 v[212:213], v241 offset:256
ds_read_b64_tr_b16 v[214:215], v241 offset:1280
s_waitcnt lgkmcnt(4)
v_mfma_f32_32x32x16_bf16 v[96:111], v[200:203], v[164:167], v[96:111]
ds_read_b64_tr_b16 v[192:193], v241 offset:512
ds_read_b64_tr_b16 v[194:195], v241 offset:1536
v_mfma_f32_32x32x16_bf16 v[112:127], v[204:207], v[164:167], v[112:127]
global_load_lds_dword v235, s[96:97] offset:204
ds_read_b64_tr_b16 v[196:197], v241 offset:768
ds_read_b64_tr_b16 v[198:199], v241 offset:1792
s_waitcnt lgkmcnt(4)
v_mfma_f32_32x32x16_bf16 v[0:15], v[208:211], v[168:171], v[0:15]
ds_read_b64_tr_b16 v[200:201], v241 offset:8192
ds_read_b64_tr_b16 v[202:203], v241 offset:9216
v_mfma_f32_32x32x16_bf16 v[16:31], v[212:215], v[168:171], v[16:31]
ds_read_b64_tr_b16 v[204:205], v241 offset:8448
ds_read_b64_tr_b16 v[206:207], v241 offset:9472
s_waitcnt lgkmcnt(4)
v_mfma_f32_32x32x16_bf16 v[32:47], v[192:195], v[168:171], v[32:47]
ds_read_b64_tr_b16 v[208:209], v241 offset:8704
ds_read_b64_tr_b16 v[210:211], v241 offset:9728
v_mfma_f32_32x32x16_bf16 v[48:63], v[196:199], v[168:171], v[48:63]
ds_read_b64_tr_b16 v[212:213], v241 offset:8960
ds_read_b64_tr_b16 v[214:215], v241 offset:9984
s_waitcnt lgkmcnt(4)
v_mfma_f32_32x32x16_bf16 v[64:79], v[200:203], v[168:171], v[64:79]
ds_read_b64_tr_b16 v[192:193], v241 offset:4096
ds_read_b64_tr_b16 v[194:195], v241 offset:5120
v_mfma_f32_32x32x16_bf16 v[80:95], v[204:207], v[168:171], v[80:95]
ds_read_b64_tr_b16 v[196:197], v241 offset:4352
ds_read_b64_tr_b16 v[198:199], v241 offset:5376
s_waitcnt lgkmcnt(4)
v_mfma_f32_32x32x16_bf16 v[96:111], v[208:211], v[168:171], v[96:111]
ds_read_b64_tr_b16 v[200:201], v241 offset:4608
ds_read_b64_tr_b16 v[202:203], v241 offset:5632
v_mfma_f32_32x32x16_bf16 v[112:127], v[212:215], v[168:171], v[112:127]
ds_read_b64_tr_b16 v[204:205], v241 offset:4864
ds_read_b64_tr_b16 v[206:207], v241 offset:5888
s_waitcnt lgkmcnt(4)
v_mfma_f32_32x32x16_bf16 v[0:15], v[192:195], v[172:175], v[0:15]
ds_read_b64_tr_b16 v[208:209], v241 offset:12288
ds_read_b64_tr_b16 v[210:211], v241 offset:13312
v_mfma_f32_32x32x16_bf16 v[16:31], v[196:199], v[172:175], v[16:31]
ds_read_b32 v238, v236 offset:448
ds_read_b64_tr_b16 v[212:213], v241 offset:12544
ds_read_b64_tr_b16 v[214:215], v241 offset:13568
s_waitcnt lgkmcnt(5)
v_mfma_f32_32x32x16_bf16 v[32:47], v[200:203], v[172:175], v[32:47]
ds_read_b64_tr_b16 v[192:193], v241 offset:12800
ds_read_b64_tr_b16 v[194:195], v241 offset:13824
v_mfma_f32_32x32x16_bf16 v[48:63], v[204:207], v[172:175], v[48:63]
ds_read_b64_tr_b16 v[196:197], v241 offset:13056
ds_read_b64_tr_b16 v[198:199], v241 offset:14080
s_waitcnt lgkmcnt(4)
v_mfma_f32_32x32x16_bf16 v[64:79], v[208:211], v[172:175], v[64:79]
v_cmp_ne_u32 vcc, 1, v238
s_nop 0
s_cbranch_vccnz L_spin14
L_back14:
v_add_u32 v242, 86016, v230
ds_read_b128 v[176:179], v242 offset:0
v_add_u32 v243, 102400, v228
ds_read_b64_tr_b16 v[200:201], v243 offset:0
ds_read_b64_tr_b16 v[202:203], v243 offset:1024
v_mfma_f32_32x32x16_bf16 v[80:95], v[212:215], v[172:175], v[80:95]
ds_read_b64_tr_b16 v[204:205], v243 offset:256
ds_read_b64_tr_b16 v[206:207], v243 offset:1280
s_waitcnt lgkmcnt(5)
v_mfma_f32_32x32x16_bf16 v[96:111], v[192:195], v[172:175], v[96:111]
ds_read_b64_tr_b16 v[208:209], v243 offset:512
ds_read_b64_tr_b16 v[210:211], v243 offset:1536
v_mfma_f32_32x32x16_bf16 v[112:127], v[196:199], v[172:175], v[112:127]
global_load_lds_dword v235, s[96:97] offset:200
ds_read_b64_tr_b16 v[212:213], v243 offset:768
ds_read_b64_tr_b16 v[214:215], v243 offset:1792
s_waitcnt lgkmcnt(4)
v_mfma_f32_32x32x16_bf16 v[0:15], v[200:203], v[176:179], v[0:15]
ds_read_b64_tr_b16 v[192:193], v243 offset:8192
ds_read_b64_tr_b16 v[194:195], v243 offset:9216
v_mfma_f32_32x32x16_bf16 v[16:31], v[204:207], v[176:179], v[16:31]
ds_read_b64_tr_b16 v[196:197], v243 offset:8448
ds_read_b64_tr_b16 v[198:199], v243 offset:9472
s_waitcnt lgkmcnt(4)
v_mfma_f32_32x32x16_bf16 v[32:47], v[208:211], v[176:179], v[32:47]
ds_read_b64_tr_b16 v[200:201], v243 offset:8704
ds_read_b64_tr_b16 v[202:203], v243 offset:9728
ds_read_b128 v[184:187], v242 offset:512
v_mfma_f32_32x32x16_bf16 v[48:63], v[212:215], v[176:179], v[48:63]
ds_read_b64_tr_b16 v[204:205], v243 offset:8960
ds_read_b64_tr_b16 v[206:207], v243 offset:9984
s_waitcnt lgkmcnt(5)
v_mfma_f32_32x32x16_bf16 v[64:79], v[192:195], v[176:179], v[64:79]
v_add_u32 v239, 86016, v231
ds_read_b128 v[180:183], v239 offset:0
ds_read_b64_tr_b16 v[208:209], v243 offset:4096
ds_read_b64_tr_b16 v[210:211], v243 offset:5120
v_mfma_f32_32x32x16_bf16 v[80:95], v[196:199], v[176:179], v[80:95]
ds_read_b64_tr_b16 v[212:213], v243 offset:4352
ds_read_b64_tr_b16 v[214:215], v243 offset:5376
s_waitcnt lgkmcnt(5)
v_mfma_f32_32x32x16_bf16 v[96:111], v[200:203], v[176:179], v[96:111]
ds_read_b64_tr_b16 v[192:193], v243 offset:4608
ds_read_b64_tr_b16 v[194:195], v243 offset:5632
v_mfma_f32_32x32x16_bf16 v[112:127], v[204:207], v[176:179], v[112:127]
ds_read_b64_tr_b16 v[196:197], v243 offset:4864
ds_read_b64_tr_b16 v[198:199], v243 offset:5888
s_waitcnt lgkmcnt(4)
v_mfma_f32_32x32x16_bf16 v[0:15], v[208:211], v[180:183], v[0:15]
ds_read_b64_tr_b16 v[200:201], v243 offset:12288
ds_read_b64_tr_b16 v[202:203], v243 offset:13312
v_mfma_f32_32x32x16_bf16 v[16:31], v[212:215], v[180:183], v[16:31]
ds_read_b32 v238, v236 offset:480
ds_read_b64_tr_b16 v[204:205], v243 offset:12544
ds_read_b64_tr_b16 v[206:207], v243 offset:13568
s_waitcnt lgkmcnt(5)
v_mfma_f32_32x32x16_bf16 v[32:47], v[192:195], v[180:183], v[32:47]
ds_read_b64_tr_b16 v[208:209], v243 offset:12800
ds_read_b64_tr_b16 v[210:211], v243 offset:13824
ds_read_b128 v[188:191], v239 offset:512
v_mfma_f32_32x32x16_bf16 v[48:63], v[196:199], v[180:183], v[48:63]
ds_read_b64_tr_b16 v[212:213], v243 offset:13056
ds_read_b64_tr_b16 v[214:215], v243 offset:14080
s_waitcnt lgkmcnt(5)
v_mfma_f32_32x32x16_bf16 v[64:79], v[200:203], v[180:183], v[64:79]
v_cmp_ne_u32 vcc, 1, v238
s_nop 0
s_cbranch_vccnz L_spin15
L_back15:
v_add_u32 v240, 118784, v228
ds_read_b64_tr_b16 v[192:193], v240 offset:0
ds_read_b64_tr_b16 v[194:195], v240 offset:1024
v_mfma_f32_32x32x16_bf16 v[80:95], v[204:207], v[180:183], v[80:95]
ds_read_b64_tr_b16 v[196:197], v240 offset:256
ds_read_b64_tr_b16 v[198:199], v240 offset:1280
s_waitcnt lgkmcnt(4)
v_mfma_f32_32x32x16_bf16 v[96:111], v[208:211], v[180:183], v[96:111]
ds_read_b64_tr_b16 v[200:201], v240 offset:512
ds_read_b64_tr_b16 v[202:203], v240 offset:1536
v_mfma_f32_32x32x16_bf16 v[112:127], v[212:215], v[180:183], v[112:127]
global_load_lds_dword v235, s[96:97] offset:196
ds_read_b64_tr_b16 v[204:205], v240 offset:768
ds_read_b64_tr_b16 v[206:207], v240 offset:1792
s_waitcnt lgkmcnt(4)
v_mfma_f32_32x32x16_bf16 v[0:15], v[192:195], v[184:187], v[0:15]
ds_read_b64_tr_b16 v[208:209], v240 offset:8192
ds_read_b64_tr_b16 v[210:211], v240 offset:9216
v_mfma_f32_32x32x16_bf16 v[16:31], v[196:199], v[184:187], v[16:31]
ds_read_b64_tr_b16 v[212:213], v240 offset:8448
ds_read_b64_tr_b16 v[214:215], v240 offset:9472
s_waitcnt lgkmcnt(4)
v_mfma_f32_32x32x16_bf16 v[32:47], v[200:203], v[184:187], v[32:47]
ds_read_b64_tr_b16 v[192:193], v240 offset:8704
ds_read_b64_tr_b16 v[194:195], v240 offset:9728
v_mfma_f32_32x32x16_bf16 v[48:63], v[204:207], v[184:187], v[48:63]
ds_read_b64_tr_b16 v[196:197], v240 offset:8960
ds_read_b64_tr_b16 v[198:199], v240 offset:9984
s_waitcnt lgkmcnt(4)
v_mfma_f32_32x32x16_bf16 v[64:79], v[208:211], v[184:187], v[64:79]
ds_read_b64_tr_b16 v[200:201], v240 offset:4096
ds_read_b64_tr_b16 v[202:203], v240 offset:5120
v_mfma_f32_32x32x16_bf16 v[80:95], v[212:215], v[184:187], v[80:95]
ds_read_b64_tr_b16 v[204:205], v240 offset:4352
ds_read_b64_tr_b16 v[206:207], v240 offset:5376
s_waitcnt lgkmcnt(4)
v_mfma_f32_32x32x16_bf16 v[96:111], v[192:195], v[184:187], v[96:111]
ds_read_b64_tr_b16 v[208:209], v240 offset:4608
ds_read_b64_tr_b16 v[210:211], v240 offset:5632
v_mfma_f32_32x32x16_bf16 v[112:127], v[196:199], v[184:187], v[112:127]
ds_read_b64_tr_b16 v[212:213], v240 offset:4864
ds_read_b64_tr_b16 v[214:215], v240 offset:5888
s_waitcnt lgkmcnt(4)
v_mfma_f32_32x32x16_bf16 v[0:15], v[200:203], v[188:191], v[0:15]
ds_read_b64_tr_b16 v[192:193], v240 offset:12288
ds_read_b64_tr_b16 v[194:195], v240 offset:13312
v_mfma_f32_32x32x16_bf16 v[16:31], v[204:207], v[188:191], v[16:31]
ds_read_b32 v238, v236 offset:512
ds_read_b64_tr_b16 v[196:197], v240 offset:12544
ds_read_b64_tr_b16 v[198:199], v240 offset:13568
s_waitcnt lgkmcnt(5)
v_mfma_f32_32x32x16_bf16 v[32:47], v[208:211], v[188:191], v[32:47]
ds_read_b64_tr_b16 v[200:201], v240 offset:12800
ds_read_b64_tr_b16 v[202:203], v240 offset:13824
v_mfma_f32_32x32x16_bf16 v[48:63], v[212:215], v[188:191], v[48:63]
ds_read_b64_tr_b16 v[204:205], v240 offset:13056
ds_read_b64_tr_b16 v[206:207], v240 offset:14080
s_waitcnt lgkmcnt(4)
v_mfma_f32_32x32x16_bf16 v[64:79], v[192:195], v[188:191], v[64:79]
v_cmp_ne_u32 vcc, 1, v238
s_nop 0
s_cbranch_vccnz L_spin16
L_back16:
v_add_u32 v241, 135168, v230
ds_read_b128 v[160:163], v241 offset:0
v_add_u32 v242, 4096, v228
ds_read_b64_tr_b16 v[208:209], v242 offset:0
ds_read_b64_tr_b16 v[210:211], v242 offset:1024
v_mfma_f32_32x32x16_bf16 v[80:95], v[196:199], v[188:191], v[80:95]
ds_read_b64_tr_b16 v[212:213], v242 offset:256
ds_read_b64_tr_b16 v[214:215], v242 offset:1280
s_waitcnt lgkmcnt(5)
v_mfma_f32_32x32x16_bf16 v[96:111], v[200:203], v[188:191], v[96:111]
ds_read_b64_tr_b16 v[192:193], v242 offset:512
ds_read_b64_tr_b16 v[194:195], v242 offset:1536
v_mfma_f32_32x32x16_bf16 v[112:127], v[204:207], v[188:191], v[112:127]
global_load_lds_dword v235, s[96:97] offset:192
ds_read_b64_tr_b16 v[196:197], v242 offset:768
ds_read_b64_tr_b16 v[198:199], v242 offset:1792
s_waitcnt lgkmcnt(4)
v_mfma_f32_32x32x16_bf16 v[0:15], v[208:211], v[160:163], v[0:15]
ds_read_b64_tr_b16 v[200:201], v242 offset:8192
ds_read_b64_tr_b16 v[202:203], v242 offset:9216
v_mfma_f32_32x32x16_bf16 v[16:31], v[212:215], v[160:163], v[16:31]
ds_read_b64_tr_b16 v[204:205], v242 offset:8448
ds_read_b64_tr_b16 v[206:207], v242 offset:9472
s_waitcnt lgkmcnt(4)
v_mfma_f32_32x32x16_bf16 v[32:47], v[192:195], v[160:163], v[32:47]
ds_read_b64_tr_b16 v[208:209], v242 offset:8704
ds_read_b64_tr_b16 v[210:211], v242 offset:9728
ds_read_b128 v[168:171], v241 offset:512
v_mfma_f32_32x32x16_bf16 v[48:63], v[196:199], v[160:163], v[48:63]
ds_read_b64_tr_b16 v[212:213], v242 offset:8960
ds_read_b64_tr_b16 v[214:215], v242 offset:9984
s_waitcnt lgkmcnt(5)
v_mfma_f32_32x32x16_bf16 v[64:79], v[200:203], v[160:163], v[64:79]
v_add_u32 v243, 135168, v231
ds_read_b128 v[164:167], v243 offset:0
ds_read_b64_tr_b16 v[192:193], v242 offset:4096
ds_read_b64_tr_b16 v[194:195], v242 offset:5120
v_mfma_f32_32x32x16_bf16 v[80:95], v[204:207], v[160:163], v[80:95]
ds_read_b64_tr_b16 v[196:197], v242 offset:4352
ds_read_b64_tr_b16 v[198:199], v242 offset:5376
s_waitcnt lgkmcnt(5)
v_mfma_f32_32x32x16_bf16 v[96:111], v[208:211], v[160:163], v[96:111]
ds_read_b64_tr_b16 v[200:201], v242 offset:4608
ds_read_b64_tr_b16 v[202:203], v242 offset:5632
v_mfma_f32_32x32x16_bf16 v[112:127], v[212:215], v[160:163], v[112:127]
ds_read_b64_tr_b16 v[204:205], v242 offset:4864
ds_read_b64_tr_b16 v[206:207], v242 offset:5888
s_waitcnt lgkmcnt(4)
v_mfma_f32_32x32x16_bf16 v[0:15], v[192:195], v[164:167], v[0:15]
ds_read_b64_tr_b16 v[208:209], v242 offset:12288
ds_read_b64_tr_b16 v[210:211], v242 offset:13312
v_mfma_f32_32x32x16_bf16 v[16:31], v[196:199], v[164:167], v[16:31]
ds_read_b32 v238, v236 offset:544
ds_read_b64_tr_b16 v[212:213], v242 offset:12544
ds_read_b64_tr_b16 v[214:215], v242 offset:13568
s_waitcnt lgkmcnt(5)
v_mfma_f32_32x32x16_bf16 v[32:47], v[200:203], v[164:167], v[32:47]
ds_read_b64_tr_b16 v[192:193], v242 offset:12800
ds_read_b64_tr_b16 v[194:195], v242 offset:13824
ds_read_b128 v[172:175], v243 offset:512
s_waitcnt vmcnt(4)
v_cmp_eq_u32 vcc, 0, v253
s_nop 0
s_cbranch_vccnz L_tagspin
L_tagok:
v_readfirstlane_b32 s56, v253
v_mfma_f32_32x32x16_bf16 v[48:63], v[204:207], v[164:167], v[48:63]
ds_read_b64_tr_b16 v[196:197], v242 offset:13056
ds_read_b64_tr_b16 v[198:199], v242 offset:14080
s_waitcnt lgkmcnt(5)
v_mfma_f32_32x32x16_bf16 v[64:79], v[208:211], v[164:167], v[64:79]
v_cmp_ne_u32 vcc, 1, v238
s_nop 0
s_cbranch_vccnz L_spin17
L_back17:
v_add_u32 v239, 20480, v228
ds_read_b64_tr_b16 v[200:201], v239 offset:0
ds_read_b64_tr_b16 v[202:203], v239 offset:1024
v_mfma_f32_32x32x16_bf16 v[80:95], v[212:215], v[164:167], v[80:95]
ds_read_b64_tr_b16 v[204:205], v239 offset:256
ds_read_b64_tr_b16 v[206:207], v239 offset:1280
s_waitcnt lgkmcnt(4)
v_mfma_f32_32x32x16_bf16 v[96:111], v[192:195], v[164:167], v[96:111]
ds_read_b64_tr_b16 v[208:209], v239 offset:512
ds_read_b64_tr_b16 v[210:211], v239 offset:1536
v_mfma_f32_32x32x16_bf16 v[112:127], v[196:199], v[164:167], v[112:127]
global_load_lds_dword v235, s[96:97] offset:188
ds_read_b64_tr_b16 v[212:213], v239 offset:768
ds_read_b64_tr_b16 v[214:215], v239 offset:1792
s_waitcnt lgkmcnt(4)
v_mfma_f32_32x32x16_bf16 v[0:15], v[200:203], v[168:171], v[0:15]
ds_read_b64_tr_b16 v[192:193], v239 offset:4096
ds_read_b64_tr_b16 v[194:195], v239 offset:5120
v_mfma_f32_32x32x16_bf16 v[16:31], v[204:207], v[168:171], v[16:31]
ds_read_b64_tr_b16 v[196:197], v239 offset:4352
ds_read_b64_tr_b16 v[198:199], v239 offset:5376
s_waitcnt lgkmcnt(4)
v_mfma_f32_32x32x16_bf16 v[32:47], v[208:211], v[168:171], v[32:47]
ds_read_b64_tr_b16 v[200:201], v239 offset:4608
ds_read_b64_tr_b16 v[202:203], v239 offset:5632
v_mfma_f32_32x32x16_bf16 v[48:63], v[212:215], v[168:171], v[48:63]
ds_read_b64_tr_b16 v[204:205], v239 offset:4864
ds_read_b64_tr_b16 v[206:207], v239 offset:5888
s_waitcnt lgkmcnt(4)
v_mfma_f32_32x32x16_bf16 v[0:15], v[192:195], v[172:175], v[0:15]
ds_read_b64_tr_b16 v[208:209], v239 offset:8192
ds_read_b64_tr_b16 v[210:211], v239 offset:9216
v_mfma_f32_32x32x16_bf16 v[16:31], v[196:199], v[172:175], v[16:31]
ds_read_b64_tr_b16 v[212:213], v239 offset:8448
ds_read_b64_tr_b16 v[214:215], v239 offset:9472
s_waitcnt lgkmcnt(4)
v_mfma_f32_32x32x16_bf16 v[32:47], v[200:203], v[172:175], v[32:47]
ds_read_b64_tr_b16 v[192:193], v239 offset:8704
ds_read_b64_tr_b16 v[194:195], v239 offset:9728
s_nop 2
v_cvt_pk_bf16_f32 v128, v0, v1
v_cvt_pk_bf16_f32 v129, v2, v3
v_mfma_f32_32x32x16_bf16 v[48:63], v[204:207], v[172:175], v[48:63]
ds_read_b64_tr_b16 v[196:197], v239 offset:8960
ds_read_b64_tr_b16 v[198:199], v239 offset:9984
v_cvt_pk_bf16_f32 v130, v4, v5
v_cvt_pk_bf16_f32 v131, v6, v7
s_waitcnt lgkmcnt(4)
v_mfma_f32_32x32x16_bf16 v[64:79], v[208:211], v[168:171], v[64:79]
ds_read_b64_tr_b16 v[200:201], v239 offset:12288
ds_read_b64_tr_b16 v[202:203], v239 offset:13312
v_cvt_pk_bf16_f32 v132, v8, v9
v_cvt_pk_bf16_f32 v133, v10, v11
v_mfma_f32_32x32x16_bf16 v[80:95], v[212:215], v[168:171], v[80:95]
ds_read_b32 v238, v236 offset:576
ds_read_b64_tr_b16 v[204:205], v239 offset:12544
ds_read_b64_tr_b16 v[206:207], v239 offset:13568
v_cvt_pk_bf16_f32 v134, v12, v13
s_waitcnt lgkmcnt(5)
v_mfma_f32_32x32x16_bf16 v[96:111], v[192:195], v[168:171], v[96:111]
ds_read_b64_tr_b16 v[208:209], v239 offset:12800
ds_read_b64_tr_b16 v[210:211], v239 offset:13824
v_cvt_pk_bf16_f32 v135, v14, v15
v_cvt_pk_bf16_f32 v136, v16, v17
v_mfma_f32_32x32x16_bf16 v[112:127], v[196:199], v[168:171], v[112:127]
ds_read_b64_tr_b16 v[212:213], v239 offset:13056
ds_read_b64_tr_b16 v[214:215], v239 offset:14080
v_cvt_pk_bf16_f32 v137, v18, v19
v_cvt_pk_bf16_f32 v138, v20, v21
s_waitcnt lgkmcnt(4)
v_mfma_f32_32x32x16_bf16 v[64:79], v[200:203], v[172:175], v[64:79]
v_cmp_ne_u32 vcc, 1, v238
s_nop 0
s_cbranch_vccnz L_spin18
L_back18:
v_add_u32 v240, 36864, v232
ds_read_b128 v[192:195], v240 offset:0
v_mfma_f32_32x32x16_bf16 v[80:95], v[204:207], v[172:175], v[80:95]
v_add_u32 v241, 36864, v233
ds_read_b128 v[196:199], v241 offset:0
v_cvt_pk_bf16_f32 v139, v22, v23
v_cvt_pk_bf16_f32 v140, v24, v25
s_waitcnt lgkmcnt(2)
v_mfma_f32_32x32x16_bf16 v[96:111], v[208:211], v[172:175], v[96:111]
ds_read_b128 v[200:203], v240 offset:256
v_cvt_pk_bf16_f32 v141, v26, v27
v_cvt_pk_bf16_f32 v142, v28, v29
v_cvt_pk_bf16_f32 v143, v30, v31
v_mfma_f32_32x32x16_bf16 v[112:127], v[212:215], v[172:175], v[112:127]
global_load_lds_dword v235, s[96:97] offset:184
ds_read_b128 v[204:207], v241 offset:256
v_cvt_pk_bf16_f32 v144, v32, v33
v_cvt_pk_bf16_f32 v145, v34, v35
s_waitcnt lgkmcnt(2)
v_mfma_f32_32x32x16_bf16 v[0:15], v[192:195], v[128:131], 0
ds_read_b128 v[208:211], v240 offset:512
v_cvt_pk_bf16_f32 v146, v36, v37
v_cvt_pk_bf16_f32 v147, v38, v39
v_cvt_pk_bf16_f32 v148, v40, v41
v_mfma_f32_32x32x16_bf16 v[0:15], v[196:199], v[132:135], v[0:15]
ds_read_b128 v[212:215], v241 offset:512
v_cvt_pk_bf16_f32 v149, v42, v43
v_cvt_pk_bf16_f32 v150, v44, v45
v_cvt_pk_bf16_f32 v151, v46, v47
s_waitcnt lgkmcnt(2)
v_mfma_f32_32x32x16_bf16 v[0:15], v[200:203], v[136:139], v[0:15]
ds_read_b128 v[192:195], v240 offset:768
v_cvt_pk_bf16_f32 v152, v48, v49
v_cvt_pk_bf16_f32 v153, v50, v51
v_cvt_pk_bf16_f32 v154, v52, v53
v_mfma_f32_32x32x16_bf16 v[0:15], v[204:207], v[140:143], v[0:15]
ds_read_b128 v[196:199], v241 offset:768
v_cvt_pk_bf16_f32 v155, v54, v55
v_cvt_pk_bf16_f32 v156, v56, v57
v_cvt_pk_bf16_f32 v157, v58, v59
s_waitcnt lgkmcnt(2)
v_mfma_f32_32x32x16_bf16 v[0:15], v[208:211], v[144:147], v[0:15]
ds_read_b128 v[200:203], v240 offset:8192
v_cvt_pk_bf16_f32 v158, v60, v61
v_cvt_pk_bf16_f32 v159, v62, v63
v_cvt_pk_bf16_f32 v160, v64, v65
v_mfma_f32_32x32x16_bf16 v[0:15], v[212:215], v[148:151], v[0:15]
ds_read_b128 v[204:207], v241 offset:8192
v_cvt_pk_bf16_f32 v161, v66, v67
v_cvt_pk_bf16_f32 v162, v68, v69
v_cvt_pk_bf16_f32 v163, v70, v71
s_waitcnt lgkmcnt(2)
v_mfma_f32_32x32x16_bf16 v[0:15], v[192:195], v[152:155], v[0:15]
ds_read_b128 v[208:211], v240 offset:8448
v_cvt_pk_bf16_f32 v164, v72, v73
v_cvt_pk_bf16_f32 v165, v74, v75
v_cvt_pk_bf16_f32 v166, v76, v77
v_mfma_f32_32x32x16_bf16 v[0:15], v[196:199], v[156:159], v[0:15]
ds_read_b128 v[212:215], v241 offset:8448
v_cvt_pk_bf16_f32 v167, v78, v79
v_cvt_pk_bf16_f32 v168, v80, v81
v_cvt_pk_bf16_f32 v169, v82, v83
s_waitcnt lgkmcnt(2)
v_mfma_f32_32x32x16_bf16 v[16:31], v[200:203], v[128:131], 0
ds_read_b128 v[192:195], v240 offset:8704
v_cvt_pk_bf16_f32 v170, v84, v85
v_cvt_pk_bf16_f32 v171, v86, v87
v_cvt_pk_bf16_f32 v172, v88, v89
v_mfma_f32_32x32x16_bf16 v[16:31], v[204:207], v[132:135], v[16:31]
ds_read_b32 v238, v236 offset:608
ds_read_b128 v[196:199], v241 offset:8704
v_cvt_pk_bf16_f32 v173, v90, v91
v_cvt_pk_bf16_f32 v174, v92, v93
s_waitcnt lgkmcnt(3)
v_mfma_f32_32x32x16_bf16 v[16:31], v[208:211], v[136:139], v[16:31]
ds_read_b128 v[200:203], v240 offset:8960
v_cvt_pk_bf16_f32 v175, v94, v95
v_cvt_pk_bf16_f32 v176, v96, v97
v_cvt_pk_bf16_f32 v177, v98, v99
v_mfma_f32_32x32x16_bf16 v[16:31], v[212:215], v[140:143], v[16:31]
ds_read_b128 v[204:207], v241 offset:8960
v_cvt_pk_bf16_f32 v178, v100, v101
v_cvt_pk_bf16_f32 v179, v102, v103
v_cvt_pk_bf16_f32 v180, v104, v105
s_waitcnt lgkmcnt(2)
v_mfma_f32_32x32x16_bf16 v[16:31], v[192:195], v[144:147], v[16:31]
v_cmp_ne_u32 vcc, 1, v238
s_nop 0
s_cbranch_vccnz L_spin19
L_back19:
v_add_u32 v242, 53248, v232
ds_read_b128 v[208:211], v242 offset:0
v_mfma_f32_32x32x16_bf16 v[16:31], v[196:199], v[148:151], v[16:31]
v_add_u32 v243, 53248, v233
ds_read_b128 v[212:215], v243 offset:0
v_cvt_pk_bf16_f32 v181, v106, v107
v_cvt_pk_bf16_f32 v182, v108, v109
s_waitcnt lgkmcnt(2)
v_mfma_f32_32x32x16_bf16 v[16:31], v[200:203], v[152:155], v[16:31]
ds_read_b128 v[192:195], v242 offset:256
v_cvt_pk_bf16_f32 v183, v110, v111
v_cvt_pk_bf16_f32 v184, v112, v113
v_cvt_pk_bf16_f32 v185, v114, v115
v_mfma_f32_32x32x16_bf16 v[16:31], v[204:207], v[156:159], v[16:31]
global_load_lds_dword v235, s[96:97] offset:180
ds_read_b128 v[196:199], v243 offset:256
v_cvt_pk_bf16_f32 v186, v116, v117
v_cvt_pk_bf16_f32 v187, v118, v119
s_waitcnt lgkmcnt(2)
v_mfma_f32_32x32x16_bf16 v[32:47], v[208:211], v[128:131], 0
ds_read_b128 v[200:203], v242 offset:512
v_cvt_pk_bf16_f32 v188, v120, v121
v_cvt_pk_bf16_f32 v189, v122, v123
v_cvt_pk_bf16_f32 v190, v124, v125
v_mfma_f32_32x32x16_bf16 v[32:47], v[212:215], v[132:135], v[32:47]
ds_read_b128 v[204:207], v243 offset:512
v_cvt_pk_bf16_f32 v191, v126, v127
v_max_f32 v244, v0, v1
v_max3_f32 v244, v244, v2, v3
s_waitcnt lgkmcnt(2)
v_mfma_f32_32x32x16_bf16 v[32:47], v[192:195], v[136:139], v[32:47]
ds_read_b128 v[208:211], v242 offset:768
v_max3_f32 v244, v244, v4, v5
v_max3_f32 v244, v244, v6, v7
v_max3_f32 v244, v244, v8, v9
v_mfma_f32_32x32x16_bf16 v[32:47], v[196:199], v[140:143], v[32:47]
ds_read_b128 v[212:215], v243 offset:768
v_max3_f32 v244, v244, v10, v11
v_max3_f32 v244, v244, v12, v13
v_max3_f32 v244, v244, v14, v15
s_waitcnt lgkmcnt(2)
v_mfma_f32_32x32x16_bf16 v[32:47], v[200:203], v[144:147], v[32:47]
ds_read_b128 v[192:195], v242 offset:8192
v_max_f32 v245, v16, v17
v_max3_f32 v245, v245, v18, v19
v_max3_f32 v245, v245, v20, v21
v_mfma_f32_32x32x16_bf16 v[32:47], v[204:207], v[148:151], v[32:47]
ds_read_b128 v[196:199], v243 offset:8192
v_max3_f32 v245, v245, v22, v23
v_max3_f32 v245, v245, v24, v25
v_max3_f32 v245, v245, v26, v27
s_waitcnt lgkmcnt(2)
v_mfma_f32_32x32x16_bf16 v[32:47], v[208:211], v[152:155], v[32:47]
ds_read_b128 v[200:203], v242 offset:8448
v_max3_f32 v245, v245, v28, v29
v_max3_f32 v245, v245, v30, v31
v_mfma_f32_32x32x16_bf16 v[32:47], v[212:215], v[156:159], v[32:47]
ds_read_b128 v[204:207], v243 offset:8448
s_waitcnt lgkmcnt(2)
v_mfma_f32_32x32x16_bf16 v[48:63], v[192:195], v[128:131], 0
ds_read_b128 v[208:211], v242 offset:8704
v_mfma_f32_32x32x16_bf16 v[48:63], v[196:199], v[132:135], v[48:63]
ds_read_b32 v238, v236 offset:640
ds_read_b128 v[212:215], v243 offset:8704
s_nop 4
v_max3_f32 v244, v244, v32, v33
v_max3_f32 v244, v244, v34, v35
s_waitcnt lgkmcnt(3)
v_mfma_f32_32x32x16_bf16 v[48:63], v[200:203], v[136:139], v[48:63]
ds_read_b128 v[192:195], v242 offset:8960
v_max3_f32 v244, v244, v36, v37
v_max3_f32 v244, v244, v38, v39
v_max3_f32 v244, v244, v40, v41
v_mfma_f32_32x32x16_bf16 v[48:63], v[204:207], v[140:143], v[48:63]
ds_read_b128 v[196:199], v243 offset:8960
v_max3_f32 v244, v244, v42, v43
v_max3_f32 v244, v244, v44, v45
v_max3_f32 v244, v244, v46, v47
s_waitcnt lgkmcnt(2)
v_mfma_f32_32x32x16_bf16 v[48:63], v[208:211], v[144:147], v[48:63]
v_cmp_ne_u32 vcc, 1, v238
s_nop 0
s_cbranch_vccnz L_spin20
L_back20:
v_add_u32 v239, 69632, v232
ds_read_b128 v[200:203], v239 offset:0
v_mfma_f32_32x32x16_bf16 v[48:63], v[212:215], v[148:151], v[48:63]
v_add_u32 v240, 69632, v233
ds_read_b128 v[204:207], v240 offset:0
s_waitcnt lgkmcnt(2)
v_mfma_f32_32x32x16_bf16 v[48:63], v[192:195], v[152:155], v[48:63]
ds_read_b128 v[208:211], v239 offset:256
v_mfma_f32_32x32x16_bf16 v[48:63], v[196:199], v[156:159], v[48:63]
global_load_lds_dword v235, s[96:97] offset:176
ds_read_b128 v[212:215], v240 offset:256
s_waitcnt lgkmcnt(2)
v_mfma_f32_32x32x16_bf16 v[64:79], v[200:203], v[160:163], 0
ds_read_b128 v[192:195], v239 offset:512
v_mfma_f32_32x32x16_bf16 v[64:79], v[204:207], v[164:167], v[64:79]
ds_read_b128 v[196:199], v240 offset:512
s_nop 4
v_max3_f32 v245, v245, v48, v49
v_max3_f32 v245, v245, v50, v51
v_max3_f32 v245, v245, v52, v53
s_waitcnt lgkmcnt(2)
v_mfma_f32_32x32x16_bf16 v[64:79], v[208:211], v[168:171], v[64:79]
ds_read_b128 v[200:203], v239 offset:768
v_max3_f32 v245, v245, v54, v55
v_max3_f32 v245, v245, v56, v57
v_max3_f32 v245, v245, v58, v59
v_mfma_f32_32x32x16_bf16 v[64:79], v[212:215], v[172:175], v[64:79]
ds_read_b128 v[204:207], v240 offset:768
v_max3_f32 v245, v245, v60, v61
v_max3_f32 v245, v245, v62, v63
v_max_f32 v244, v244, v245
s_waitcnt lgkmcnt(2)
v_mfma_f32_32x32x16_bf16 v[64:79], v[192:195], v[176:179], v[64:79]
ds_read_b128 v[208:211], v239 offset:8192
v_mov_b32 v245, v244
s_nop 1
v_permlane32_swap_b32 v244, v245
v_max_f32 v244, v244, v245
v_mfma_f32_32x32x16_bf16 v[64:79], v[196:199], v[180:183], v[64:79]
ds_read_b128 v[212:215], v240 offset:8192
v_mul_f32 v246, s58, v244
v_fma_f32 v0, v0, s58, -v246
v_fma_f32 v1, v1, s58, -v246
s_waitcnt lgkmcnt(2)
v_mfma_f32_32x32x16_bf16 v[64:79], v[200:203], v[184:187], v[64:79]
ds_read_b128 v[192:195], v239 offset:8448
v_exp_f32 v0, v0
v_exp_f32 v1, v1
v_mfma_f32_32x32x16_bf16 v[64:79], v[204:207], v[188:191], v[64:79]
ds_read_b128 v[196:199], v240 offset:8448
v_fma_f32 v2, v2, s58, -v246
v_fma_f32 v3, v3, s58, -v246
v_exp_f32 v2, v2
s_waitcnt lgkmcnt(2)
v_mfma_f32_32x32x16_bf16 v[80:95], v[208:211], v[160:163], 0
ds_read_b128 v[200:203], v239 offset:8704
v_exp_f32 v3, v3
v_mov_b32 v244, v0
v_mov_b32 v245, v1
v_mfma_f32_32x32x16_bf16 v[80:95], v[212:215], v[164:167], v[80:95]
ds_read_b32 v238, v236 offset:672
ds_read_b128 v[204:207], v240 offset:8704
v_cvt_pk_bf16_f32 v128, v0, v1
v_fma_f32 v4, v4, s58, -v246
v_fma_f32 v5, v5, s58, -v246
s_waitcnt lgkmcnt(3)
v_mfma_f32_32x32x16_bf16 v[80:95], v[192:195], v[168:171], v[80:95]
ds_read_b128 v[208:211], v239 offset:8960
v_exp_f32 v4, v4
v_exp_f32 v5, v5
v_mfma_f32_32x32x16_bf16 v[80:95], v[196:199], v[172:175], v[80:95]
ds_read_b128 v[212:215], v240 offset:8960
v_add_f32 v244, v244, v2
v_add_f32 v245, v245, v3
v_cvt_pk_bf16_f32 v129, v2, v3
s_waitcnt lgkmcnt(2)
v_mfma_f32_32x32x16_bf16 v[80:95], v[200:203], v[176:179], v[80:95]
v_cmp_ne_u32 vcc, 1, v238
s_nop 0
s_cbranch_vccnz L_spin21
L_back21:
v_add_u32 v241, 86016, v232
ds_read_b128 v[192:195], v241 offset:0
v_mfma_f32_32x32x16_bf16 v[80:95], v[204:207], v[180:183], v[80:95]
v_add_u32 v242, 86016, v233
ds_read_b128 v[196:199], v242 offset:0
v_fma_f32 v6, v6, s58, -v246
v_fma_f32 v7, v7, s58, -v246
s_waitcnt lgkmcnt(2)
v_mfma_f32_32x32x16_bf16 v[80:95], v[208:211], v[184:187], v[80:95]
ds_read_b128 v[200:203], v241 offset:256
v_exp_f32 v6, v6
v_exp_f32 v7, v7
v_mfma_f32_32x32x16_bf16 v[80:95], v[212:215], v[188:191], v[80:95]
global_load_lds_dword v235, s[96:97] offset:172
ds_read_b128 v[204:207], v242 offset:256
v_add_f32 v244, v244, v4
v_add_f32 v245, v245, v5
s_waitcnt lgkmcnt(2)
v_mfma_f32_32x32x16_bf16 v[96:111], v[192:195], v[160:163], 0
ds_read_b128 v[208:211], v241 offset:512
v_cvt_pk_bf16_f32 v130, v4, v5
v_fma_f32 v8, v8, s58, -v246
v_fma_f32 v9, v9, s58, -v246
v_mfma_f32_32x32x16_bf16 v[96:111], v[196:199], v[164:167], v[96:111]
ds_read_b128 v[212:215], v242 offset:512
v_exp_f32 v8, v8
v_exp_f32 v9, v9
s_waitcnt lgkmcnt(2)
v_mfma_f32_32x32x16_bf16 v[96:111], v[200:203], v[168:171], v[96:111]
ds_read_b128 v[192:195], v241 offset:768
v_add_f32 v244, v244, v6
v_add_f32 v245, v245, v7
v_cvt_pk_bf16_f32 v131, v6, v7
v_mfma_f32_32x32x16_bf16 v[96:111], v[204:207], v[172:175], v[96:111]
ds_read_b128 v[196:199], v242 offset:768
v_fma_f32 v10, v10, s58, -v246
v_fma_f32 v11, v11, s58, -v246
v_exp_f32 v10, v10
s_waitcnt lgkmcnt(2)
v_mfma_f32_32x32x16_bf16 v[96:111], v[208:211], v[176:179], v[96:111]
ds_read_b128 v[200:203], v241 offset:8192
v_exp_f32 v11, v11
v_add_f32 v244, v244, v8
v_add_f32 v245, v245, v9
v_mfma_f32_32x32x16_bf16 v[96:111], v[212:215], v[180:183], v[96:111]
ds_read_b128 v[204:207], v242 offset:8192
v_cvt_pk_bf16_f32 v132, v8, v9
v_fma_f32 v12, v12, s58, -v246
v_fma_f32 v13, v13, s58, -v246
s_waitcnt lgkmcnt(2)
v_mfma_f32_32x32x16_bf16 v[96:111], v[192:195], v[184:187], v[96:111]
ds_read_b128 v[208:211], v241 offset:8448
v_exp_f32 v12, v12
v_exp_f32 v13, v13
v_mfma_f32_32x32x16_bf16 v[96:111], v[196:199], v[188:191], v[96:111]
ds_read_b128 v[212:215], v242 offset:8448
v_add_f32 v244, v244, v10
v_add_f32 v245, v245, v11
v_cvt_pk_bf16_f32 v133, v10, v11
s_waitcnt lgkmcnt(2)
v_mfma_f32_32x32x16_bf16 v[112:127], v[200:203], v[160:163], 0
ds_read_b128 v[192:195], v241 offset:8704
v_fma_f32 v14, v14, s58, -v246
v_fma_f32 v15, v15, s58, -v246
v_exp_f32 v14, v14
v_mfma_f32_32x32x16_bf16 v[112:127], v[204:207], v[164:167], v[112:127]
ds_read_b128 v[196:199], v242 offset:8704
v_exp_f32 v15, v15
v_add_f32 v244, v244, v12
v_add_f32 v245, v245, v13
s_waitcnt lgkmcnt(2)
v_mfma_f32_32x32x16_bf16 v[112:127], v[208:211], v[168:171], v[112:127]
ds_read_b128 v[200:203], v241 offset:8960
v_cvt_pk_bf16_f32 v134, v12, v13
v_fma_f32 v16, v16, s58, -v246
v_fma_f32 v17, v17, s58, -v246
v_mfma_f32_32x32x16_bf16 v[112:127], v[212:215], v[172:175], v[112:127]
ds_read_b128 v[204:207], v242 offset:8960
v_exp_f32 v16, v16
v_exp_f32 v17, v17
s_waitcnt lgkmcnt(2)
v_mfma_f32_32x32x16_bf16 v[112:127], v[192:195], v[176:179], v[112:127]
v_add_f32 v244, v244, v14
v_add_f32 v245, v245, v15
v_cvt_pk_bf16_f32 v135, v14, v15
v_fma_f32 v18, v18, s58, -v246
v_fma_f32 v19, v19, s58, -v246
v_mfma_f32_32x32x16_bf16 v[112:127], v[196:199], v[180:183], v[112:127]
v_exp_f32 v18, v18
v_exp_f32 v19, v19
s_waitcnt lgkmcnt(0)
v_mfma_f32_32x32x16_bf16 v[112:127], v[200:203], v[184:187], v[112:127]
v_add_f32 v244, v244, v16
v_add_f32 v245, v245, v17
v_cvt_pk_bf16_f32 v136, v16, v17
v_fma_f32 v20, v20, s58, -v246
v_fma_f32 v21, v21, s58, -v246
v_mfma_f32_32x32x16_bf16 v[112:127], v[204:207], v[188:191], v[112:127]
global_load_lds_dword v235, s[96:97] offset:168
v_exp_f32 v20, v20
v_exp_f32 v21, v21
v_pk_add_f32 v[244:245], v[244:245], v[18:19]
v_cvt_pk_bf16_f32 v137, v18, v19
v_pk_fma_f32 v[22:23], v[22:23], s[58:59], v[246:247] op_sel_hi:[1,0,0] neg_lo:[0,0,1] neg_hi:[0,0,1]
v_exp_f32 v22, v22
v_exp_f32 v23, v23
v_pk_add_f32 v[244:245], v[244:245], v[20:21]
v_cvt_pk_bf16_f32 v138, v20, v21
v_pk_fma_f32 v[24:25], v[24:25], s[58:59], v[246:247] op_sel_hi:[1,0,0] neg_lo:[0,0,1] neg_hi:[0,0,1]
v_exp_f32 v24, v24
v_exp_f32 v25, v25
v_pk_add_f32 v[244:245], v[244:245], v[22:23]
v_cvt_pk_bf16_f32 v139, v22, v23
v_pk_fma_f32 v[26:27], v[26:27], s[58:59], v[246:247] op_sel_hi:[1,0,0] neg_lo:[0,0,1] neg_hi:[0,0,1]
v_exp_f32 v26, v26
v_exp_f32 v27, v27
v_pk_add_f32 v[244:245], v[244:245], v[24:25]
v_cvt_pk_bf16_f32 v140, v24, v25
v_pk_fma_f32 v[28:29], v[28:29], s[58:59], v[246:247] op_sel_hi:[1,0,0] neg_lo:[0,0,1] neg_hi:[0,0,1]
v_exp_f32 v28, v28
v_exp_f32 v29, v29
v_pk_add_f32 v[244:245], v[244:245], v[26:27]
v_cvt_pk_bf16_f32 v141, v26, v27
v_pk_fma_f32 v[30:31], v[30:31], s[58:59], v[246:247] op_sel_hi:[1,0,0] neg_lo:[0,0,1] neg_hi:[0,0,1]
v_exp_f32 v30, v30
v_exp_f32 v31, v31
v_pk_add_f32 v[244:245], v[244:245], v[28:29]
v_cvt_pk_bf16_f32 v142, v28, v29
v_pk_fma_f32 v[32:33], v[32:33], s[58:59], v[246:247] op_sel_hi:[1,0,0] neg_lo:[0,0,1] neg_hi:[0,0,1]
v_exp_f32 v32, v32
v_exp_f32 v33, v33
v_pk_add_f32 v[244:245], v[244:245], v[30:31]
v_cvt_pk_bf16_f32 v143, v30, v31
v_pk_fma_f32 v[34:35], v[34:35], s[58:59], v[246:247] op_sel_hi:[1,0,0] neg_lo:[0,0,1] neg_hi:[0,0,1]
v_exp_f32 v34, v34
v_exp_f32 v35, v35
v_pk_add_f32 v[244:245], v[244:245], v[32:33]
v_cvt_pk_bf16_f32 v144, v32, v33
v_pk_fma_f32 v[36:37], v[36:37], s[58:59], v[246:247] op_sel_hi:[1,0,0] neg_lo:[0,0,1] neg_hi:[0,0,1]
v_exp_f32 v36, v36
v_exp_f32 v37, v37
v_pk_add_f32 v[244:245], v[244:245], v[34:35]
v_cvt_pk_bf16_f32 v145, v34, v35
v_pk_fma_f32 v[38:39], v[38:39], s[58:59], v[246:247] op_sel_hi:[1,0,0] neg_lo:[0,0,1] neg_hi:[0,0,1]
v_exp_f32 v38, v38
v_exp_f32 v39, v39
v_pk_add_f32 v[244:245], v[244:245], v[36:37]
v_cvt_pk_bf16_f32 v146, v36, v37
v_pk_fma_f32 v[40:41], v[40:41], s[58:59], v[246:247] op_sel_hi:[1,0,0] neg_lo:[0,0,1] neg_hi:[0,0,1]
v_exp_f32 v40, v40
v_exp_f32 v41, v41
v_pk_add_f32 v[244:245], v[244:245], v[38:39]
v_cvt_pk_bf16_f32 v147, v38, v39
v_pk_fma_f32 v[42:43], v[42:43], s[58:59], v[246:247] op_sel_hi:[1,0,0] neg_lo:[0,0,1] neg_hi:[0,0,1]
v_exp_f32 v42, v42
v_exp_f32 v43, v43
v_pk_add_f32 v[244:245], v[244:245], v[40:41]
v_cvt_pk_bf16_f32 v148, v40, v41
v_pk_fma_f32 v[44:45], v[44:45], s[58:59], v[246:247] op_sel_hi:[1,0,0] neg_lo:[0,0,1] neg_hi:[0,0,1]
v_exp_f32 v44, v44
v_exp_f32 v45, v45
v_pk_add_f32 v[244:245], v[244:245], v[42:43]
v_cvt_pk_bf16_f32 v149, v42, v43
v_pk_fma_f32 v[46:47], v[46:47], s[58:59], v[246:247] op_sel_hi:[1,0,0] neg_lo:[0,0,1] neg_hi:[0,0,1]
v_exp_f32 v46, v46
v_exp_f32 v47, v47
v_pk_add_f32 v[244:245], v[244:245], v[44:45]
v_cvt_pk_bf16_f32 v150, v44, v45
v_pk_fma_f32 v[48:49], v[48:49], s[58:59], v[246:247] op_sel_hi:[1,0,0] neg_lo:[0,0,1] neg_hi:[0,0,1]
v_exp_f32 v48, v48
v_exp_f32 v49, v49
v_pk_add_f32 v[244:245], v[244:245], v[46:47]
v_cvt_pk_bf16_f32 v151, v46, v47
v_pk_fma_f32 v[50:51], v[50:51], s[58:59], v[246:247] op_sel_hi:[1,0,0] neg_lo:[0,0,1] neg_hi:[0,0,1]
v_exp_f32 v50, v50
v_exp_f32 v51, v51
v_pk_add_f32 v[244:245], v[244:245], v[48:49]
v_cvt_pk_bf16_f32 v152, v48, v49
v_pk_fma_f32 v[52:53], v[52:53], s[58:59], v[246:247] op_sel_hi:[1,0,0] neg_lo:[0,0,1] neg_hi:[0,0,1]
v_exp_f32 v52, v52
ds_read_b32 v238, v236 offset:704
s_waitcnt lgkmcnt(0)
v_cmp_ne_u32 vcc, 1, v238
s_nop 0
s_cbranch_vccnz L_spin22
L_back22:
v_add_u32 v243, 102400, v228
ds_read_b64_tr_b16 v[208:209], v243 offset:0
ds_read_b64_tr_b16 v[210:211], v243 offset:1024
ds_read_b64_tr_b16 v[212:213], v243 offset:256
ds_read_b64_tr_b16 v[214:215], v243 offset:1280
ds_read_b64_tr_b16 v[192:193], v243 offset:512
ds_read_b64_tr_b16 v[194:195], v243 offset:1536
ds_read_b64_tr_b16 v[196:197], v243 offset:768
ds_read_b64_tr_b16 v[198:199], v243 offset:1792
v_exp_f32 v53, v53
v_pk_add_f32 v[244:245], v[244:245], v[50:51]
v_cvt_pk_bf16_f32 v153, v50, v51
v_pk_fma_f32 v[54:55], v[54:55], s[58:59], v[246:247] op_sel_hi:[1,0,0] neg_lo:[0,0,1] neg_hi:[0,0,1]
v_exp_f32 v54, v54
v_exp_f32 v55, v55
v_pk_add_f32 v[244:245], v[244:245], v[52:53]
v_cvt_pk_bf16_f32 v154, v52, v53
v_pk_fma_f32 v[56:57], v[56:57], s[58:59], v[246:247] op_sel_hi:[1,0,0] neg_lo:[0,0,1] neg_hi:[0,0,1]
v_exp_f32 v56, v56
v_exp_f32 v57, v57
v_pk_add_f32 v[244:245], v[244:245], v[54:55]
v_cvt_pk_bf16_f32 v155, v54, v55
v_pk_fma_f32 v[58:59], v[58:59], s[58:59], v[246:247] op_sel_hi:[1,0,0] neg_lo:[0,0,1] neg_hi:[0,0,1]
v_exp_f32 v58, v58
v_exp_f32 v59, v59
v_pk_add_f32 v[244:245], v[244:245], v[56:57]
v_cvt_pk_bf16_f32 v156, v56, v57
v_pk_fma_f32 v[60:61], v[60:61], s[58:59], v[246:247] op_sel_hi:[1,0,0] neg_lo:[0,0,1] neg_hi:[0,0,1]
v_exp_f32 v60, v60
v_exp_f32 v61, v61
v_pk_add_f32 v[244:245], v[244:245], v[58:59]
v_cvt_pk_bf16_f32 v157, v58, v59
v_pk_fma_f32 v[62:63], v[62:63], s[58:59], v[246:247] op_sel_hi:[1,0,0] neg_lo:[0,0,1] neg_hi:[0,0,1]
v_exp_f32 v62, v62
v_exp_f32 v63, v63
v_pk_add_f32 v[244:245], v[244:245], v[60:61]
v_cvt_pk_bf16_f32 v158, v60, v61
v_pk_add_f32 v[244:245], v[244:245], v[62:63]
v_cvt_pk_bf16_f32 v159, v62, v63
s_waitcnt lgkmcnt(4)
v_mfma_f32_32x32x16_bf16 v[0:15], v[208:211], v[128:131], 0
ds_read_b64_tr_b16 v[200:201], v243 offset:4096
ds_read_b64_tr_b16 v[202:203], v243 offset:5120
v_add_f32 v250, v244, v245
v_mov_b32 v251, v250
v_mfma_f32_32x32x16_bf16 v[16:31], v[212:215], v[128:131], 0
ds_read_b64_tr_b16 v[204:205], v243 offset:4352
ds_read_b64_tr_b16 v[206:207], v243 offset:5376
v_permlane32_swap_b32 v250, v251
v_add_f32 v250, v250, v251
s_waitcnt lgkmcnt(4)
v_mfma_f32_32x32x16_bf16 v[32:47], v[192:195], v[128:131], 0
ds_read_b64_tr_b16 v[208:209], v243 offset:4608
ds_read_b64_tr_b16 v[210:211], v243 offset:5632
v_rcp_f32 v250, v250
v_mfma_f32_32x32x16_bf16 v[48:63], v[196:199], v[128:131], 0
ds_read_b64_tr_b16 v[212:213], v243 offset:4864
ds_read_b64_tr_b16 v[214:215], v243 offset:5888
v_max_f32 v244, v64, v65
v_max3_f32 v244, v244, v66, v67
s_waitcnt lgkmcnt(4)
v_mfma_f32_32x32x16_bf16 v[0:15], v[200:203], v[132:135], v[0:15]
ds_read_b64_tr_b16 v[192:193], v243 offset:8192
ds_read_b64_tr_b16 v[194:195], v243 offset:9216
v_max3_f32 v244, v244, v68, v69
v_max3_f32 v244, v244, v70, v71
v_mfma_f32_32x32x16_bf16 v[16:31], v[204:207], v[132:135], v[16:31]
ds_read_b64_tr_b16 v[196:197], v243 offset:8448
ds_read_b64_tr_b16 v[198:199], v243 offset:9472
v_max3_f32 v244, v244, v72, v73
v_max3_f32 v244, v244, v74, v75
s_waitcnt lgkmcnt(4)
v_mfma_f32_32x32x16_bf16 v[32:47], v[208:211], v[132:135], v[32:47]
ds_read_b64_tr_b16 v[200:201], v243 offset:8704
ds_read_b64_tr_b16 v[202:203], v243 offset:9728
v_max3_f32 v244, v244, v76, v77
v_max3_f32 v244, v244, v78, v79
v_mfma_f32_32x32x16_bf16 v[48:63], v[212:215], v[132:135], v[48:63]
ds_read_b64_tr_b16 v[204:205], v243 offset:8960
ds_read_b64_tr_b16 v[206:207], v243 offset:9984
v_max_f32 v245, v80, v81
v_max3_f32 v245, v245, v82, v83
s_waitcnt lgkmcnt(4)
v_mfma_f32_32x32x16_bf16 v[0:15], v[192:195], v[136:139], v[0:15]
ds_read_b64_tr_b16 v[208:209], v243 offset:12288
ds_read_b64_tr_b16 v[210:211], v243 offset:13312
v_max3_f32 v245, v245, v84, v85
v_max3_f32 v245, v245, v86, v87
v_mfma_f32_32x32x16_bf16 v[16:31], v[196:199], v[136:139], v[16:31]
ds_read_b32 v238, v236 offset:736
ds_read_b64_tr_b16 v[212:213], v243 offset:12544
ds_read_b64_tr_b16 v[214:215], v243 offset:13568
v_max3_f32 v245, v245, v88, v89
s_waitcnt lgkmcnt(5)
v_mfma_f32_32x32x16_bf16 v[32:47], v[200:203], v[136:139], v[32:47]
ds_read_b64_tr_b16 v[192:193], v243 offset:12800
ds_read_b64_tr_b16 v[194:195], v243 offset:13824
v_max3_f32 v245, v245, v90, v91
v_max3_f32 v245, v245, v92, v93
v_mfma_f32_32x32x16_bf16 v[48:63], v[204:207], v[136:139], v[48:63]
ds_read_b64_tr_b16 v[196:197], v243 offset:13056
ds_read_b64_tr_b16 v[198:199], v243 offset:14080
v_max3_f32 v245, v245, v94, v95
v_max3_f32 v244, v244, v96, v97
s_waitcnt lgkmcnt(4)
v_mfma_f32_32x32x16_bf16 v[0:15], v[208:211], v[140:143], v[0:15]
v_cmp_ne_u32 vcc, 1, v238
s_nop 0
s_cbranch_vccnz L_spin23
L_back23:
v_add_u32 v239, 118784, v228
ds_read_b64_tr_b16 v[200:201], v239 offset:0
ds_read_b64_tr_b16 v[202:203], v239 offset:1024
v_mfma_f32_32x32x16_bf16 v[16:31], v[212:215], v[140:143], v[16:31]
ds_read_b64_tr_b16 v[204:205], v239 offset:256
ds_read_b64_tr_b16 v[206:207], v239 offset:1280
v_max3_f32 v244, v244, v98, v99
v_max3_f32 v244, v244, v100, v101
s_waitcnt lgkmcnt(4)
v_mfma_f32_32x32x16_bf16 v[32:47], v[192:195], v[140:143], v[32:47]
ds_read_b64_tr_b16 v[208:209], v239 offset:512
ds_read_b64_tr_b16 v[210:211], v239 offset:1536
v_max3_f32 v244, v244, v102, v103
v_max3_f32 v244, v244, v104, v105
v_mfma_f32_32x32x16_bf16 v[48:63], v[196:199], v[140:143], v[48:63]
global_load_lds_dword v235, s[96:97] offset:164
ds_read_b64_tr_b16 v[212:213], v239 offset:768
ds_read_b64_tr_b16 v[214:215], v239 offset:1792
v_max3_f32 v244, v244, v106, v107
s_waitcnt lgkmcnt(4)
v_mfma_f32_32x32x16_bf16 v[0:15], v[200:203], v[144:147], v[0:15]
ds_read_b64_tr_b16 v[192:193], v239 offset:4096
ds_read_b64_tr_b16 v[194:195], v239 offset:5120
v_max3_f32 v244, v244, v108, v109
v_max3_f32 v244, v244, v110, v111
v_mfma_f32_32x32x16_bf16 v[16:31], v[204:207], v[144:147], v[16:31]
ds_read_b64_tr_b16 v[196:197], v239 offset:4352
ds_read_b64_tr_b16 v[198:199], v239 offset:5376
v_max3_f32 v245, v245, v112, v113
v_max3_f32 v245, v245, v114, v115
s_waitcnt lgkmcnt(4)
v_mfma_f32_32x32x16_bf16 v[32:47], v[208:211], v[144:147], v[32:47]
ds_read_b64_tr_b16 v[200:201], v239 offset:4608
ds_read_b64_tr_b16 v[202:203], v239 offset:5632
v_max3_f32 v245, v245, v116, v117
v_max3_f32 v245, v245, v118, v119
v_mfma_f32_32x32x16_bf16 v[48:63], v[212:215], v[144:147], v[48:63]
ds_read_b64_tr_b16 v[204:205], v239 offset:4864
ds_read_b64_tr_b16 v[206:207], v239 offset:5888
v_max3_f32 v245, v245, v120, v121
v_max3_f32 v245, v245, v122, v123
s_waitcnt lgkmcnt(4)
v_mfma_f32_32x32x16_bf16 v[0:15], v[192:195], v[148:151], v[0:15]
ds_read_b64_tr_b16 v[208:209], v239 offset:8192
ds_read_b64_tr_b16 v[210:211], v239 offset:9216
v_max3_f32 v245, v245, v124, v125
v_max3_f32 v245, v245, v126, v127
v_mfma_f32_32x32x16_bf16 v[16:31], v[196:199], v[148:151], v[16:31]
ds_read_b64_tr_b16 v[212:213], v239 offset:8448
ds_read_b64_tr_b16 v[214:215], v239 offset:9472
v_max_f32 v244, v244, v245
v_mov_b32 v245, v244
s_waitcnt lgkmcnt(4)
v_mfma_f32_32x32x16_bf16 v[32:47], v[200:203], v[148:151], v[32:47]
ds_read_b64_tr_b16 v[192:193], v239 offset:8704
ds_read_b64_tr_b16 v[194:195], v239 offset:9728
v_permlane32_swap_b32 v244, v245
v_max_f32 v244, v244, v245
v_mfma_f32_32x32x16_bf16 v[48:63], v[204:207], v[148:151], v[48:63]
ds_read_b64_tr_b16 v[196:197], v239 offset:8960
ds_read_b64_tr_b16 v[198:199], v239 offset:9984
v_mul_f32 v246, s58, v244
v_fma_f32 v64, v64, s58, -v246
v_fma_f32 v65, v65, s58, -v246
s_waitcnt lgkmcnt(4)
v_mfma_f32_32x32x16_bf16 v[0:15], v[208:211], v[152:155], v[0:15]
ds_read_b64_tr_b16 v[200:201], v239 offset:12288
ds_read_b64_tr_b16 v[202:203], v239 offset:13312
v_exp_f32 v64, v64
v_mfma_f32_32x32x16_bf16 v[16:31], v[212:215], v[152:155], v[16:31]
ds_read_b64_tr_b16 v[204:205], v239 offset:12544
ds_read_b64_tr_b16 v[206:207], v239 offset:13568
v_exp_f32 v65, v65
s_waitcnt lgkmcnt(4)
v_mfma_f32_32x32x16_bf16 v[32:47], v[192:195], v[152:155], v[32:47]
ds_read_b64_tr_b16 v[208:209], v239 offset:12800
ds_read_b64_tr_b16 v[210:211], v239 offset:13824
v_fma_f32 v66, v66, s58, -v246
v_fma_f32 v67, v67, s58, -v246
v_mfma_f32_32x32x16_bf16 v[48:63], v[196:199], v[152:155], v[48:63]
ds_read_b64_tr_b16 v[212:213], v239 offset:13056
ds_read_b64_tr_b16 v[214:215], v239 offset:14080
v_exp_f32 v66, v66
s_waitcnt lgkmcnt(4)
v_mfma_f32_32x32x16_bf16 v[0:15], v[200:203], v[156:159], v[0:15]
v_exp_f32 v67, v67
v_mov_b32 v244, v64
v_mov_b32 v245, v65
v_mfma_f32_32x32x16_bf16 v[16:31], v[204:207], v[156:159], v[16:31]
v_cvt_pk_bf16_f32 v160, v64, v65
v_fma_f32 v68, v68, s58, -v246
v_fma_f32 v69, v69, s58, -v246
v_exp_f32 v68, v68
s_waitcnt lgkmcnt(0)
v_mfma_f32_32x32x16_bf16 v[32:47], v[208:211], v[156:159], v[32:47]
v_exp_f32 v69, v69
v_add_f32 v244, v244, v66
v_add_f32 v245, v245, v67
v_mfma_f32_32x32x16_bf16 v[48:63], v[212:215], v[156:159], v[48:63]
global_load_lds_dword v235, s[96:97] offset:160
v_cvt_pk_bf16_f32 v161, v66, v67
v_fma_f32 v70, v70, s58, -v246
v_fma_f32 v71, v71, s58, -v246
v_exp_f32 v70, v70
v_exp_f32 v71, v71
v_pk_add_f32 v[244:245], v[244:245], v[68:69]
v_cvt_pk_bf16_f32 v162, v68, v69
v_pk_fma_f32 v[72:73], v[72:73], s[58:59], v[246:247] op_sel_hi:[1,0,0] neg_lo:[0,0,1] neg_hi:[0,0,1]
v_exp_f32 v72, v72
v_exp_f32 v73, v73
v_pk_add_f32 v[244:245], v[244:245], v[70:71]
v_cvt_pk_bf16_f32 v163, v70, v71
v_pk_mul_f32 v[0:1], v[0:1], v[250:251] op_sel_hi:[1,0]
v_pk_mul_f32 v[2:3], v[2:3], v[250:251] op_sel_hi:[1,0]
v_pk_mul_f32 v[4:5], v[4:5], v[250:251] op_sel_hi:[1,0]
v_pk_mul_f32 v[6:7], v[6:7], v[250:251] op_sel_hi:[1,0]
v_cvt_pk_bf16_f32 v128, v0, v1
v_cvt_pk_bf16_f32 v129, v2, v3
v_cvt_pk_bf16_f32 v130, v4, v5
v_cvt_pk_bf16_f32 v131, v6, v7
v_pk_mul_f32 v[8:9], v[8:9], v[250:251] op_sel_hi:[1,0]
v_pk_mul_f32 v[10:11], v[10:11], v[250:251] op_sel_hi:[1,0]
v_pk_mul_f32 v[12:13], v[12:13], v[250:251] op_sel_hi:[1,0]
v_pk_mul_f32 v[14:15], v[14:15], v[250:251] op_sel_hi:[1,0]
v_cvt_pk_bf16_f32 v132, v8, v9
v_cvt_pk_bf16_f32 v133, v10, v11
v_cvt_pk_bf16_f32 v134, v12, v13
v_cvt_pk_bf16_f32 v135, v14, v15
v_pk_mul_f32 v[16:17], v[16:17], v[250:251] op_sel_hi:[1,0]
v_pk_mul_f32 v[18:19], v[18:19], v[250:251] op_sel_hi:[1,0]
v_pk_mul_f32 v[20:21], v[20:21], v[250:251] op_sel_hi:[1,0]
v_pk_mul_f32 v[22:23], v[22:23], v[250:251] op_sel_hi:[1,0]
v_cvt_pk_bf16_f32 v136, v16, v17
v_cvt_pk_bf16_f32 v137, v18, v19
v_cvt_pk_bf16_f32 v138, v20, v21
v_cvt_pk_bf16_f32 v139, v22, v23
v_pk_mul_f32 v[24:25], v[24:25], v[250:251] op_sel_hi:[1,0]
v_pk_mul_f32 v[26:27], v[26:27], v[250:251] op_sel_hi:[1,0]
v_pk_mul_f32 v[28:29], v[28:29], v[250:251] op_sel_hi:[1,0]
v_pk_mul_f32 v[30:31], v[30:31], v[250:251] op_sel_hi:[1,0]
v_cvt_pk_bf16_f32 v140, v24, v25
v_cvt_pk_bf16_f32 v141, v26, v27
v_cvt_pk_bf16_f32 v142, v28, v29
v_cvt_pk_bf16_f32 v143, v30, v31
v_pk_mul_f32 v[32:33], v[32:33], v[250:251] op_sel_hi:[1,0]
v_pk_mul_f32 v[34:35], v[34:35], v[250:251] op_sel_hi:[1,0]
ds_read_b32 v238, v236 offset:768
s_waitcnt lgkmcnt(0)
v_cmp_ne_u32 vcc, 1, v238
s_nop 0
s_cbranch_vccnz L_spin24
L_back24:
v_add_u32 v240, 4096, v228
ds_read_b64_tr_b16 v[192:193], v240 offset:0
ds_read_b64_tr_b16 v[194:195], v240 offset:1024
ds_read_b64_tr_b16 v[196:197], v240 offset:256
ds_read_b64_tr_b16 v[198:199], v240 offset:1280
ds_read_b64_tr_b16 v[200:201], v240 offset:512
ds_read_b64_tr_b16 v[202:203], v240 offset:1536
ds_read_b64_tr_b16 v[204:205], v240 offset:768
ds_read_b64_tr_b16 v[206:207], v240 offset:1792
v_pk_mul_f32 v[36:37], v[36:37], v[250:251] op_sel_hi:[1,0]
v_pk_mul_f32 v[38:39], v[38:39], v[250:251] op_sel_hi:[1,0]
v_cvt_pk_bf16_f32 v144, v32, v33
v_cvt_pk_bf16_f32 v145, v34, v35
v_cvt_pk_bf16_f32 v146, v36, v37
v_cvt_pk_bf16_f32 v147, v38, v39
v_pk_mul_f32 v[40:41], v[40:41], v[250:251] op_sel_hi:[1,0]
v_pk_mul_f32 v[42:43], v[42:43], v[250:251] op_sel_hi:[1,0]
v_pk_mul_f32 v[44:45], v[44:45], v[250:251] op_sel_hi:[1,0]
v_pk_mul_f32 v[46:47], v[46:47], v[250:251] op_sel_hi:[1,0]
v_cvt_pk_bf16_f32 v148, v40, v41
v_cvt_pk_bf16_f32 v149, v42, v43
v_cvt_pk_bf16_f32 v150, v44, v45
v_cvt_pk_bf16_f32 v151, v46, v47
v_pk_mul_f32 v[48:49], v[48:49], v[250:251] op_sel_hi:[1,0]
v_pk_mul_f32 v[50:51], v[50:51], v[250:251] op_sel_hi:[1,0]
v_pk_mul_f32 v[52:53], v[52:53], v[250:251] op_sel_hi:[1,0]
v_pk_mul_f32 v[54:55], v[54:55], v[250:251] op_sel_hi:[1,0]
v_cvt_pk_bf16_f32 v152, v48, v49
v_cvt_pk_bf16_f32 v153, v50, v51
v_cvt_pk_bf16_f32 v154, v52, v53
v_cvt_pk_bf16_f32 v155, v54, v55
v_pk_mul_f32 v[56:57], v[56:57], v[250:251] op_sel_hi:[1,0]
v_pk_mul_f32 v[58:59], v[58:59], v[250:251] op_sel_hi:[1,0]
v_pk_mul_f32 v[60:61], v[60:61], v[250:251] op_sel_hi:[1,0]
v_pk_mul_f32 v[62:63], v[62:63], v[250:251] op_sel_hi:[1,0]
v_cvt_pk_bf16_f32 v156, v56, v57
v_cvt_pk_bf16_f32 v157, v58, v59
v_cvt_pk_bf16_f32 v158, v60, v61
v_cvt_pk_bf16_f32 v159, v62, v63
s_waitcnt lgkmcnt(4)
v_mfma_f32_32x32x16_bf16 v[0:15], v[128:131], v[192:195], 0
ds_read_b64_tr_b16 v[208:209], v240 offset:4096
ds_read_b64_tr_b16 v[210:211], v240 offset:5120
s_add_u32 s47, s48, 0
buffer_store_dwordx4 v[128:131], v237, s[32:35], s47 offen offset:0 sc1
buffer_store_dwordx4 v[132:135], v237, s[32:35], s47 offen offset:1024 sc1
buffer_store_dwordx4 v[136:139], v237, s[32:35], s47 offen offset:2048 sc1
buffer_store_dwordx4 v[140:143], v237, s[32:35], s47 offen offset:3072 sc1
s_add_u32 s47, s48, 16384
buffer_store_dwordx4 v[144:147], v237, s[32:35], s47 offen offset:0 sc1
buffer_store_dwordx4 v[148:151], v237, s[32:35], s47 offen offset:1024 sc1
buffer_store_dwordx4 v[152:155], v237, s[32:35], s47 offen offset:2048 sc1
buffer_store_dwordx4 v[156:159], v237, s[32:35], s47 offen offset:3072 sc1
v_mfma_f32_32x32x16_bf16 v[16:31], v[128:131], v[196:199], 0
ds_read_b64_tr_b16 v[212:213], v240 offset:4352
ds_read_b64_tr_b16 v[214:215], v240 offset:5376
v_fma_f32 v74, v74, s58, -v246
v_fma_f32 v75, v75, s58, -v246
s_waitcnt lgkmcnt(4)
v_mfma_f32_32x32x16_bf16 v[32:47], v[128:131], v[200:203], 0
ds_read_b64_tr_b16 v[192:193], v240 offset:4608
ds_read_b64_tr_b16 v[194:195], v240 offset:5632
v_exp_f32 v74, v74
v_mfma_f32_32x32x16_bf16 v[48:63], v[128:131], v[204:207], 0
ds_read_b64_tr_b16 v[196:197], v240 offset:4864
ds_read_b64_tr_b16 v[198:199], v240 offset:5888
v_exp_f32 v75, v75
s_waitcnt lgkmcnt(4)
v_mfma_f32_32x32x16_bf16 v[0:15], v[132:135], v[208:211], v[0:15]
ds_read_b64_tr_b16 v[200:201], v240 offset:8192
ds_read_b64_tr_b16 v[202:203], v240 offset:9216
v_add_f32 v244, v244, v72
v_add_f32 v245, v245, v73
v_mfma_f32_32x32x16_bf16 v[16:31], v[132:135], v[212:215], v[16:31]
ds_read_b64_tr_b16 v[204:205], v240 offset:8448
ds_read_b64_tr_b16 v[206:207], v240 offset:9472
v_cvt_pk_bf16_f32 v164, v72, v73
v_fma_f32 v76, v76, s58, -v246
v_fma_f32 v77, v77, s58, -v246
s_waitcnt lgkmcnt(4)
v_mfma_f32_32x32x16_bf16 v[32:47], v[132:135], v[192:195], v[32:47]
ds_read_b64_tr_b16 v[208:209], v240 offset:8704
ds_read_b64_tr_b16 v[210:211], v240 offset:9728
v_exp_f32 v76, v76
v_mfma_f32_32x32x16_bf16 v[48:63], v[132:135], v[196:199], v[48:63]
ds_read_b64_tr_b16 v[212:213], v240 offset:8960
ds_read_b64_tr_b16 v[214:215], v240 offset:9984
v_exp_f32 v77, v77
s_waitcnt lgkmcnt(4)
v_mfma_f32_32x32x16_bf16 v[0:15], v[136:139], v[200:203], v[0:15]
ds_read_b64_tr_b16 v[192:193], v240 offset:12288
ds_read_b64_tr_b16 v[194:195], v240 offset:13312
v_add_f32 v244, v244, v74
v_add_f32 v245, v245, v75
v_mfma_f32_32x32x16_bf16 v[16:31], v[136:139], v[204:207], v[16:31]
ds_read_b32 v238, v236 offset:800
ds_read_b64_tr_b16 v[196:197], v240 offset:12544
ds_read_b64_tr_b16 v[198:199], v240 offset:13568
v_cvt_pk_bf16_f32 v165, v74, v75
s_waitcnt lgkmcnt(5)
v_mfma_f32_32x32x16_bf16 v[32:47], v[136:139], v[208:211], v[32:47]
ds_read_b64_tr_b16 v[200:201], v240 offset:12800
ds_read_b64_tr_b16 v[202:203], v240 offset:13824
v_fma_f32 v78, v78, s58, -v246
v_fma_f32 v79, v79, s58, -v246
v_mfma_f32_32x32x16_bf16 v[48:63], v[136:139], v[212:215], v[48:63]
ds_read_b64_tr_b16 v[204:205], v240 offset:13056
ds_read_b64_tr_b16 v[206:207], v240 offset:14080
v_exp_f32 v78, v78
s_waitcnt lgkmcnt(4)
v_mfma_f32_32x32x16_bf16 v[0:15], v[140:143], v[192:195], v[0:15]
v_cmp_ne_u32 vcc, 1, v238
s_nop 0
s_cbranch_vccnz L_spin25
L_back25:
v_add_u32 v241, 135168, v228
ds_read_b64_tr_b16 v[208:209], v241 offset:0
ds_read_b64_tr_b16 v[210:211], v241 offset:1024
v_mfma_f32_32x32x16_bf16 v[16:31], v[140:143], v[196:199], v[16:31]
ds_read_b64_tr_b16 v[212:213], v241 offset:256
ds_read_b64_tr_b16 v[214:215], v241 offset:1280
v_exp_f32 v79, v79
s_waitcnt lgkmcnt(4)
v_mfma_f32_32x32x16_bf16 v[32:47], v[140:143], v[200:203], v[32:47]
ds_read_b64_tr_b16 v[192:193], v241 offset:512
ds_read_b64_tr_b16 v[194:195], v241 offset:1536
v_add_f32 v244, v244, v76
v_add_f32 v245, v245, v77
v_mfma_f32_32x32x16_bf16 v[48:63], v[140:143], v[204:207], v[48:63]
global_load_lds_dword v235, s[96:97] offset:156
ds_read_b64_tr_b16 v[196:197], v241 offset:768
ds_read_b64_tr_b16 v[198:199], v241 offset:1792
v_cvt_pk_bf16_f32 v166, v76, v77
s_waitcnt lgkmcnt(4)
v_mfma_f32_32x32x16_bf16 v[0:15], v[144:147], v[208:211], v[0:15]
ds_read_b64_tr_b16 v[200:201], v241 offset:4096
ds_read_b64_tr_b16 v[202:203], v241 offset:5120
v_fma_f32 v80, v80, s58, -v246
v_fma_f32 v81, v81, s58, -v246
v_mfma_f32_32x32x16_bf16 v[16:31], v[144:147], v[212:215], v[16:31]
ds_read_b64_tr_b16 v[204:205], v241 offset:4352
ds_read_b64_tr_b16 v[206:207], v241 offset:5376
v_exp_f32 v80, v80
s_waitcnt lgkmcnt(4)
v_mfma_f32_32x32x16_bf16 v[32:47], v[144:147], v[192:195], v[32:47]
ds_read_b64_tr_b16 v[208:209], v241 offset:4608
ds_read_b64_tr_b16 v[210:211], v241 offset:5632
v_exp_f32 v81, v81
v_mfma_f32_32x32x16_bf16 v[48:63], v[144:147], v[196:199], v[48:63]
ds_read_b64_tr_b16 v[212:213], v241 offset:4864
ds_read_b64_tr_b16 v[214:215], v241 offset:5888
v_add_f32 v244, v244, v78
v_add_f32 v245, v245, v79
s_waitcnt lgkmcnt(4)
v_mfma_f32_32x32x16_bf16 v[0:15], v[148:151], v[200:203], v[0:15]
ds_read_b64_tr_b16 v[192:193], v241 offset:8192
ds_read_b64_tr_b16 v[194:195], v241 offset:9216
v_cvt_pk_bf16_f32 v167, v78, v79
v_fma_f32 v82, v82, s58, -v246
v_fma_f32 v83, v83, s58, -v246
v_mfma_f32_32x32x16_bf16 v[16:31], v[148:151], v[204:207], v[16:31]
ds_read_b64_tr_b16 v[196:197], v241 offset:8448
ds_read_b64_tr_b16 v[198:199], v241 offset:9472
v_exp_f32 v82, v82
s_waitcnt lgkmcnt(4)
v_mfma_f32_32x32x16_bf16 v[32:47], v[148:151], v[208:211], v[32:47]
ds_read_b64_tr_b16 v[200:201], v241 offset:8704
ds_read_b64_tr_b16 v[202:203], v241 offset:9728
v_exp_f32 v83, v83
v_mfma_f32_32x32x16_bf16 v[48:63], v[148:151], v[212:215], v[48:63]
ds_read_b64_tr_b16 v[204:205], v241 offset:8960
ds_read_b64_tr_b16 v[206:207], v241 offset:9984
v_add_f32 v244, v244, v80
v_add_f32 v245, v245, v81
s_waitcnt lgkmcnt(4)
v_mfma_f32_32x32x16_bf16 v[0:15], v[152:155], v[192:195], v[0:15]
ds_read_b64_tr_b16 v[208:209], v241 offset:12288
ds_read_b64_tr_b16 v[210:211], v241 offset:13312
v_cvt_pk_bf16_f32 v168, v80, v81
v_fma_f32 v84, v84, s58, -v246
v_fma_f32 v85, v85, s58, -v246
v_mfma_f32_32x32x16_bf16 v[16:31], v[152:155], v[196:199], v[16:31]
ds_read_b64_tr_b16 v[212:213], v241 offset:12544
ds_read_b64_tr_b16 v[214:215], v241 offset:13568
v_exp_f32 v84, v84
s_waitcnt lgkmcnt(4)
v_mfma_f32_32x32x16_bf16 v[32:47], v[152:155], v[200:203], v[32:47]
ds_read_b64_tr_b16 v[192:193], v241 offset:12800
ds_read_b64_tr_b16 v[194:195], v241 offset:13824
v_exp_f32 v85, v85
v_mfma_f32_32x32x16_bf16 v[48:63], v[152:155], v[204:207], v[48:63]
ds_read_b64_tr_b16 v[196:197], v241 offset:13056
ds_read_b64_tr_b16 v[198:199], v241 offset:14080
v_add_f32 v244, v244, v82
v_add_f32 v245, v245, v83
s_waitcnt lgkmcnt(4)
v_mfma_f32_32x32x16_bf16 v[0:15], v[156:159], v[208:211], v[0:15]
v_cvt_pk_bf16_f32 v169, v82, v83
v_fma_f32 v86, v86, s58, -v246
v_fma_f32 v87, v87, s58, -v246
v_exp_f32 v86, v86
v_mfma_f32_32x32x16_bf16 v[16:31], v[156:159], v[212:215], v[16:31]
v_exp_f32 v87, v87
v_add_f32 v244, v244, v84
v_add_f32 v245, v245, v85
s_waitcnt lgkmcnt(0)
v_mfma_f32_32x32x16_bf16 v[32:47], v[156:159], v[192:195], v[32:47]
v_cvt_pk_bf16_f32 v170, v84, v85
v_fma_f32 v88, v88, s58, -v246
v_fma_f32 v89, v89, s58, -v246
v_exp_f32 v88, v88
v_mfma_f32_32x32x16_bf16 v[48:63], v[156:159], v[196:199], v[48:63]
global_load_lds_dword v235, s[96:97] offset:152
s_waitcnt vmcnt(2)
s_add_u32 s45, s56, 1
v_mov_b32 v254, s45
s_mov_b64 exec, 1
s_add_u32 s45, s49, 262144
buffer_store_dword v254, v235, s[32:35], s45 offen
buffer_store_dword v254, v235, s[32:35], s49 offen sc1
s_mov_b64 exec, -1
v_exp_f32 v89, v89
v_pk_add_f32 v[244:245], v[244:245], v[86:87]
v_cvt_pk_bf16_f32 v171, v86, v87
v_pk_fma_f32 v[90:91], v[90:91], s[58:59], v[246:247] op_sel_hi:[1,0,0] neg_lo:[0,0,1] neg_hi:[0,0,1]
v_exp_f32 v90, v90
v_exp_f32 v91, v91
v_pk_add_f32 v[244:245], v[244:245], v[88:89]
v_cvt_pk_bf16_f32 v172, v88, v89
v_pk_fma_f32 v[92:93], v[92:93], s[58:59], v[246:247] op_sel_hi:[1,0,0] neg_lo:[0,0,1] neg_hi:[0,0,1]
v_exp_f32 v92, v92
v_exp_f32 v93, v93
v_pk_add_f32 v[244:245], v[244:245], v[90:91]
v_cvt_pk_bf16_f32 v173, v90, v91
v_pk_fma_f32 v[94:95], v[94:95], s[58:59], v[246:247] op_sel_hi:[1,0,0] neg_lo:[0,0,1] neg_hi:[0,0,1]
v_exp_f32 v94, v94
v_exp_f32 v95, v95
v_pk_add_f32 v[244:245], v[244:245], v[92:93]
v_cvt_pk_bf16_f32 v174, v92, v93
v_pk_fma_f32 v[96:97], v[96:97], s[58:59], v[246:247] op_sel_hi:[1,0,0] neg_lo:[0,0,1] neg_hi:[0,0,1]
v_exp_f32 v96, v96
v_exp_f32 v97, v97
v_pk_add_f32 v[244:245], v[244:245], v[94:95]
v_cvt_pk_bf16_f32 v175, v94, v95
v_pk_fma_f32 v[98:99], v[98:99], s[58:59], v[246:247] op_sel_hi:[1,0,0] neg_lo:[0,0,1] neg_hi:[0,0,1]
v_exp_f32 v98, v98
v_exp_f32 v99, v99
v_pk_add_f32 v[244:245], v[244:245], v[96:97]
v_cvt_pk_bf16_f32 v176, v96, v97
v_pk_fma_f32 v[100:101], v[100:101], s[58:59], v[246:247] op_sel_hi:[1,0,0] neg_lo:[0,0,1] neg_hi:[0,0,1]
v_exp_f32 v100, v100
v_exp_f32 v101, v101
v_pk_add_f32 v[244:245], v[244:245], v[98:99]
v_cvt_pk_bf16_f32 v177, v98, v99
v_pk_fma_f32 v[102:103], v[102:103], s[58:59], v[246:247] op_sel_hi:[1,0,0] neg_lo:[0,0,1] neg_hi:[0,0,1]
v_exp_f32 v102, v102
v_exp_f32 v103, v103
v_pk_add_f32 v[244:245], v[244:245], v[100:101]
v_cvt_pk_bf16_f32 v178, v100, v101
v_pk_fma_f32 v[104:105], v[104:105], s[58:59], v[246:247] op_sel_hi:[1,0,0] neg_lo:[0,0,1] neg_hi:[0,0,1]
v_exp_f32 v104, v104
v_exp_f32 v105, v105
v_pk_add_f32 v[244:245], v[244:245], v[102:103]
v_cvt_pk_bf16_f32 v179, v102, v103
v_pk_fma_f32 v[106:107], v[106:107], s[58:59], v[246:247] op_sel_hi:[1,0,0] neg_lo:[0,0,1] neg_hi:[0,0,1]
v_exp_f32 v106, v106
v_exp_f32 v107, v107
v_pk_add_f32 v[244:245], v[244:245], v[104:105]
v_cvt_pk_bf16_f32 v180, v104, v105
v_pk_fma_f32 v[108:109], v[108:109], s[58:59], v[246:247] op_sel_hi:[1,0,0] neg_lo:[0,0,1] neg_hi:[0,0,1]
v_exp_f32 v108, v108
v_exp_f32 v109, v109
v_pk_add_f32 v[244:245], v[244:245], v[106:107]
v_cvt_pk_bf16_f32 v181, v106, v107
v_pk_fma_f32 v[110:111], v[110:111], s[58:59], v[246:247] op_sel_hi:[1,0,0] neg_lo:[0,0,1] neg_hi:[0,0,1]
v_exp_f32 v110, v110
v_exp_f32 v111, v111
v_pk_add_f32 v[244:245], v[244:245], v[108:109]
v_cvt_pk_bf16_f32 v182, v108, v109
v_pk_fma_f32 v[112:113], v[112:113], s[58:59], v[246:247] op_sel_hi:[1,0,0] neg_lo:[0,0,1] neg_hi:[0,0,1]
v_exp_f32 v112, v112
v_exp_f32 v113, v113
v_pk_add_f32 v[244:245], v[244:245], v[110:111]
v_cvt_pk_bf16_f32 v183, v110, v111
v_pk_fma_f32 v[114:115], v[114:115], s[58:59], v[246:247] op_sel_hi:[1,0,0] neg_lo:[0,0,1] neg_hi:[0,0,1]
v_exp_f32 v114, v114
v_exp_f32 v115, v115
v_pk_add_f32 v[244:245], v[244:245], v[112:113]
v_cvt_pk_bf16_f32 v184, v112, v113
v_pk_fma_f32 v[116:117], v[116:117], s[58:59], v[246:247] op_sel_hi:[1,0,0] neg_lo:[0,0,1] neg_hi:[0,0,1]
v_exp_f32 v116, v116
ds_read_b32 v238, v236 offset:832
s_waitcnt lgkmcnt(0)
v_cmp_ne_u32 vcc, 1, v238
s_nop 0
s_cbranch_vccnz L_spin26
L_back26:
v_add_u32 v242, 20480, v228
ds_read_b64_tr_b16 v[200:201], v242 offset:0
ds_read_b64_tr_b16 v[202:203], v242 offset:1024
ds_read_b64_tr_b16 v[204:205], v242 offset:256
ds_read_b64_tr_b16 v[206:207], v242 offset:1280
ds_read_b64_tr_b16 v[208:209], v242 offset:512
ds_read_b64_tr_b16 v[210:211], v242 offset:1536
ds_read_b64_tr_b16 v[212:213], v242 offset:768
ds_read_b64_tr_b16 v[214:215], v242 offset:1792
v_exp_f32 v117, v117
v_pk_add_f32 v[244:245], v[244:245], v[114:115]
v_cvt_pk_bf16_f32 v185, v114, v115
v_pk_fma_f32 v[118:119], v[118:119], s[58:59], v[246:247] op_sel_hi:[1,0,0] neg_lo:[0,0,1] neg_hi:[0,0,1]
v_exp_f32 v118, v118
v_exp_f32 v119, v119
v_pk_add_f32 v[244:245], v[244:245], v[116:117]
v_cvt_pk_bf16_f32 v186, v116, v117
v_pk_fma_f32 v[120:121], v[120:121], s[58:59], v[246:247] op_sel_hi:[1,0,0] neg_lo:[0,0,1] neg_hi:[0,0,1]
v_exp_f32 v120, v120
v_exp_f32 v121, v121
v_pk_add_f32 v[244:245], v[244:245], v[118:119]
v_cvt_pk_bf16_f32 v187, v118, v119
v_pk_fma_f32 v[122:123], v[122:123], s[58:59], v[246:247] op_sel_hi:[1,0,0] neg_lo:[0,0,1] neg_hi:[0,0,1]
v_exp_f32 v122, v122
v_exp_f32 v123, v123
v_pk_add_f32 v[244:245], v[244:245], v[120:121]
v_cvt_pk_bf16_f32 v188, v120, v121
v_pk_fma_f32 v[124:125], v[124:125], s[58:59], v[246:247] op_sel_hi:[1,0,0] neg_lo:[0,0,1] neg_hi:[0,0,1]
v_exp_f32 v124, v124
v_exp_f32 v125, v125
v_pk_add_f32 v[244:245], v[244:245], v[122:123]
v_cvt_pk_bf16_f32 v189, v122, v123
v_pk_fma_f32 v[126:127], v[126:127], s[58:59], v[246:247] op_sel_hi:[1,0,0] neg_lo:[0,0,1] neg_hi:[0,0,1]
v_exp_f32 v126, v126
v_exp_f32 v127, v127
v_pk_add_f32 v[244:245], v[244:245], v[124:125]
v_cvt_pk_bf16_f32 v190, v124, v125
v_pk_add_f32 v[244:245], v[244:245], v[126:127]
v_cvt_pk_bf16_f32 v191, v126, v127
s_waitcnt lgkmcnt(4)
v_mfma_f32_32x32x16_bf16 v[64:79], v[200:203], v[160:163], 0
ds_read_b64_tr_b16 v[192:193], v242 offset:4096
ds_read_b64_tr_b16 v[194:195], v242 offset:5120
v_add_f32 v248, v244, v245
v_mov_b32 v251, v248
v_mfma_f32_32x32x16_bf16 v[80:95], v[204:207], v[160:163], 0
ds_read_b64_tr_b16 v[196:197], v242 offset:4352
ds_read_b64_tr_b16 v[198:199], v242 offset:5376
v_permlane32_swap_b32 v248, v251
v_add_f32 v248, v248, v251
s_waitcnt lgkmcnt(4)
v_mfma_f32_32x32x16_bf16 v[96:111], v[208:211], v[160:163], 0
ds_read_b64_tr_b16 v[200:201], v242 offset:4608
ds_read_b64_tr_b16 v[202:203], v242 offset:5632
v_rcp_f32 v248, v248
v_mfma_f32_32x32x16_bf16 v[112:127], v[212:215], v[160:163], 0
ds_read_b64_tr_b16 v[204:205], v242 offset:4864
ds_read_b64_tr_b16 v[206:207], v242 offset:5888
s_waitcnt lgkmcnt(4)
v_mfma_f32_32x32x16_bf16 v[64:79], v[192:195], v[164:167], v[64:79]
ds_read_b64_tr_b16 v[208:209], v242 offset:8192
ds_read_b64_tr_b16 v[210:211], v242 offset:9216
v_mfma_f32_32x32x16_bf16 v[80:95], v[196:199], v[164:167], v[80:95]
ds_read_b64_tr_b16 v[212:213], v242 offset:8448
ds_read_b64_tr_b16 v[214:215], v242 offset:9472
s_waitcnt lgkmcnt(4)
v_mfma_f32_32x32x16_bf16 v[96:111], v[200:203], v[164:167], v[96:111]
ds_read_b64_tr_b16 v[192:193], v242 offset:8704
ds_read_b64_tr_b16 v[194:195], v242 offset:9728
v_mfma_f32_32x32x16_bf16 v[112:127], v[204:207], v[164:167], v[112:127]
ds_read_b64_tr_b16 v[196:197], v242 offset:8960
ds_read_b64_tr_b16 v[198:199], v242 offset:9984
s_waitcnt lgkmcnt(4)
v_mfma_f32_32x32x16_bf16 v[64:79], v[208:211], v[168:171], v[64:79]
ds_read_b64_tr_b16 v[200:201], v242 offset:12288
ds_read_b64_tr_b16 v[202:203], v242 offset:13312
v_mfma_f32_32x32x16_bf16 v[80:95], v[212:215], v[168:171], v[80:95]
ds_read_b32 v238, v236 offset:864
ds_read_b64_tr_b16 v[204:205], v242 offset:12544
ds_read_b64_tr_b16 v[206:207], v242 offset:13568
s_waitcnt lgkmcnt(5)
v_mfma_f32_32x32x16_bf16 v[96:111], v[192:195], v[168:171], v[96:111]
ds_read_b64_tr_b16 v[208:209], v242 offset:12800
ds_read_b64_tr_b16 v[210:211], v242 offset:13824
v_mfma_f32_32x32x16_bf16 v[112:127], v[196:199], v[168:171], v[112:127]
ds_read_b64_tr_b16 v[212:213], v242 offset:13056
ds_read_b64_tr_b16 v[214:215], v242 offset:14080
s_waitcnt lgkmcnt(4)
v_mfma_f32_32x32x16_bf16 v[64:79], v[200:203], v[172:175], v[64:79]
v_cmp_ne_u32 vcc, 1, v238
s_nop 0
s_cbranch_vccnz L_spin27
L_back27:
v_add_u32 v243, 36864, v228
ds_read_b64_tr_b16 v[192:193], v243 offset:0
ds_read_b64_tr_b16 v[194:195], v243 offset:1024
v_mfma_f32_32x32x16_bf16 v[80:95], v[204:207], v[172:175], v[80:95]
ds_read_b64_tr_b16 v[196:197], v243 offset:256
ds_read_b64_tr_b16 v[198:199], v243 offset:1280
s_waitcnt lgkmcnt(4)
v_mfma_f32_32x32x16_bf16 v[96:111], v[208:211], v[172:175], v[96:111]
ds_read_b64_tr_b16 v[200:201], v243 offset:512
ds_read_b64_tr_b16 v[202:203], v243 offset:1536
v_mfma_f32_32x32x16_bf16 v[112:127], v[212:215], v[172:175], v[112:127]
global_load_lds_dword v235, s[96:97] offset:148
ds_read_b64_tr_b16 v[204:205], v243 offset:768
ds_read_b64_tr_b16 v[206:207], v243 offset:1792
s_waitcnt lgkmcnt(4)
v_mfma_f32_32x32x16_bf16 v[64:79], v[192:195], v[176:179], v[64:79]
ds_read_b64_tr_b16 v[208:209], v243 offset:4096
ds_read_b64_tr_b16 v[210:211], v243 offset:5120
v_mfma_f32_32x32x16_bf16 v[80:95], v[196:199], v[176:179], v[80:95]
ds_read_b64_tr_b16 v[212:213], v243 offset:4352
ds_read_b64_tr_b16 v[214:215], v243 offset:5376
s_waitcnt lgkmcnt(4)
v_mfma_f32_32x32x16_bf16 v[96:111], v[200:203], v[176:179], v[96:111]
ds_read_b64_tr_b16 v[192:193], v243 offset:4608
ds_read_b64_tr_b16 v[194:195], v243 offset:5632
v_mfma_f32_32x32x16_bf16 v[112:127], v[204:207], v[176:179], v[112:127]
ds_read_b64_tr_b16 v[196:197], v243 offset:4864
ds_read_b64_tr_b16 v[198:199], v243 offset:5888
s_waitcnt lgkmcnt(4)
v_mfma_f32_32x32x16_bf16 v[64:79], v[208:211], v[180:183], v[64:79]
ds_read_b64_tr_b16 v[200:201], v243 offset:8192
ds_read_b64_tr_b16 v[202:203], v243 offset:9216
v_mfma_f32_32x32x16_bf16 v[80:95], v[212:215], v[180:183], v[80:95]
ds_read_b64_tr_b16 v[204:205], v243 offset:8448
ds_read_b64_tr_b16 v[206:207], v243 offset:9472
s_waitcnt lgkmcnt(4)
v_mfma_f32_32x32x16_bf16 v[96:111], v[192:195], v[180:183], v[96:111]
ds_read_b64_tr_b16 v[208:209], v243 offset:8704
ds_read_b64_tr_b16 v[210:211], v243 offset:9728
v_mfma_f32_32x32x16_bf16 v[112:127], v[196:199], v[180:183], v[112:127]
ds_read_b64_tr_b16 v[212:213], v243 offset:8960
ds_read_b64_tr_b16 v[214:215], v243 offset:9984
s_waitcnt lgkmcnt(4)
v_mfma_f32_32x32x16_bf16 v[64:79], v[200:203], v[184:187], v[64:79]
ds_read_b64_tr_b16 v[192:193], v243 offset:12288
ds_read_b64_tr_b16 v[194:195], v243 offset:13312
v_mfma_f32_32x32x16_bf16 v[80:95], v[204:207], v[184:187], v[80:95]
ds_read_b32 v238, v236 offset:896
ds_read_b64_tr_b16 v[196:197], v243 offset:12544
ds_read_b64_tr_b16 v[198:199], v243 offset:13568
s_waitcnt lgkmcnt(5)
v_mfma_f32_32x32x16_bf16 v[96:111], v[208:211], v[184:187], v[96:111]
ds_read_b64_tr_b16 v[200:201], v243 offset:12800
ds_read_b64_tr_b16 v[202:203], v243 offset:13824
v_mfma_f32_32x32x16_bf16 v[112:127], v[212:215], v[184:187], v[112:127]
ds_read_b64_tr_b16 v[204:205], v243 offset:13056
ds_read_b64_tr_b16 v[206:207], v243 offset:14080
s_waitcnt lgkmcnt(4)
v_mfma_f32_32x32x16_bf16 v[64:79], v[192:195], v[188:191], v[64:79]
v_cmp_ne_u32 vcc, 1, v238
s_nop 0
s_cbranch_vccnz L_spin28
L_back28:
v_add_u32 v239, 53248, v229
ds_read_b64_tr_b16 v[208:209], v239 offset:0
ds_read_b64_tr_b16 v[210:211], v239 offset:512
v_mfma_f32_32x32x16_bf16 v[80:95], v[196:199], v[188:191], v[80:95]
ds_read_b64_tr_b16 v[212:213], v239 offset:256
ds_read_b64_tr_b16 v[214:215], v239 offset:768
s_waitcnt lgkmcnt(4)
v_mfma_f32_32x32x16_bf16 v[96:111], v[200:203], v[188:191], v[96:111]
ds_read_b64_tr_b16 v[192:193], v239 offset:2048
ds_read_b64_tr_b16 v[194:195], v239 offset:2560
v_mul_f32 v64, v64, v248
v_mul_f32 v65, v65, v248
v_mfma_f32_32x32x16_bf16 v[112:127], v[204:207], v[188:191], v[112:127]
global_load_lds_dword v235, s[96:97] offset:144
ds_read_b64_tr_b16 v[196:197], v239 offset:2304
ds_read_b64_tr_b16 v[198:199], v239 offset:2816
v_mul_f32 v66, v66, v248
v_mul_f32 v67, v67, v248
s_waitcnt lgkmcnt(4)
v_mfma_f32_32x32x16_bf16 v[160:175], v[128:131], v[208:211], 0
ds_read_b64_tr_b16 v[200:201], v239 offset:4096
ds_read_b64_tr_b16 v[202:203], v239 offset:4608
v_mul_f32 v68, v68, v248
v_mul_f32 v69, v69, v248
v_mfma_f32_32x32x16_bf16 v[176:191], v[128:131], v[212:215], 0
ds_read_b64_tr_b16 v[204:205], v239 offset:4352
ds_read_b64_tr_b16 v[206:207], v239 offset:4864
v_mul_f32 v70, v70, v248
v_mul_f32 v71, v71, v248
s_waitcnt lgkmcnt(4)
v_mfma_f32_32x32x16_bf16 v[160:175], v[132:135], v[192:195], v[160:175]
ds_read_b64_tr_b16 v[208:209], v239 offset:6144
ds_read_b64_tr_b16 v[210:211], v239 offset:6656
v_cvt_pk_bf16_f32 v64, v64, v65
v_cvt_pk_bf16_f32 v65, v66, v67
v_cvt_pk_bf16_f32 v66, v68, v69
v_cvt_pk_bf16_f32 v67, v70, v71
v_mfma_f32_32x32x16_bf16 v[176:191], v[132:135], v[196:199], v[176:191]
ds_read_b64_tr_b16 v[212:213], v239 offset:6400
ds_read_b64_tr_b16 v[214:215], v239 offset:6912
s_add_u32 s47, s48, 32768
buffer_store_dwordx4 v[64:67], v237, s[32:35], s47 offen offset:0 sc1
s_waitcnt lgkmcnt(4)
v_mfma_f32_32x32x16_bf16 v[160:175], v[136:139], v[200:203], v[160:175]
ds_read_b64_tr_b16 v[192:193], v239 offset:8192
ds_read_b64_tr_b16 v[194:195], v239 offset:8704
v_mul_f32 v72, v72, v248
v_mul_f32 v73, v73, v248
v_pk_mul_f32 v[74:75], v[74:75], v[248:249] op_sel_hi:[1,0]
v_pk_mul_f32 v[76:77], v[76:77], v[248:249] op_sel_hi:[1,0]
v_pk_mul_f32 v[78:79], v[78:79], v[248:249] op_sel_hi:[1,0]
v_cvt_pk_bf16_f32 v68, v72, v73
v_cvt_pk_bf16_f32 v69, v74, v75
v_cvt_pk_bf16_f32 v70, v76, v77
v_cvt_pk_bf16_f32 v71, v78, v79
v_mfma_f32_32x32x16_bf16 v[176:191], v[136:139], v[204:207], v[176:191]
ds_read_b64_tr_b16 v[196:197], v239 offset:8448
ds_read_b64_tr_b16 v[198:199], v239 offset:8960
buffer_store_dwordx4 v[68:71], v237, s[32:35], s47 offen offset:1024 sc1
v_mul_f32 v80, v80, v248
v_mul_f32 v81, v81, v248
s_waitcnt lgkmcnt(4)
v_mfma_f32_32x32x16_bf16 v[160:175], v[140:143], v[208:211], v[160:175]
ds_read_b64_tr_b16 v[200:201], v239 offset:10240
ds_read_b64_tr_b16 v[202:203], v239 offset:10752
v_mul_f32 v82, v82, v248
v_mul_f32 v83, v83, v248
v_pk_mul_f32 v[84:85], v[84:85], v[248:249] op_sel_hi:[1,0]
v_pk_mul_f32 v[86:87], v[86:87], v[248:249] op_sel_hi:[1,0]
v_cvt_pk_bf16_f32 v72, v80, v81
v_cvt_pk_bf16_f32 v73, v82, v83
v_cvt_pk_bf16_f32 v74, v84, v85
v_cvt_pk_bf16_f32 v75, v86, v87
v_mfma_f32_32x32x16_bf16 v[176:191], v[140:143], v[212:215], v[176:191]
ds_read_b64_tr_b16 v[204:205], v239 offset:10496
ds_read_b64_tr_b16 v[206:207], v239 offset:11008
buffer_store_dwordx4 v[72:75], v237, s[32:35], s47 offen offset:2048 sc1
v_mul_f32 v88, v88, v248
v_mul_f32 v89, v89, v248
s_waitcnt lgkmcnt(4)
v_mfma_f32_32x32x16_bf16 v[160:175], v[144:147], v[192:195], v[160:175]
ds_read_b64_tr_b16 v[208:209], v239 offset:12288
ds_read_b64_tr_b16 v[210:211], v239 offset:12800
v_mul_f32 v90, v90, v248
v_mul_f32 v91, v91, v248
v_pk_mul_f32 v[92:93], v[92:93], v[248:249] op_sel_hi:[1,0]
v_pk_mul_f32 v[94:95], v[94:95], v[248:249] op_sel_hi:[1,0]
v_cvt_pk_bf16_f32 v76, v88, v89
v_cvt_pk_bf16_f32 v77, v90, v91
v_cvt_pk_bf16_f32 v78, v92, v93
v_cvt_pk_bf16_f32 v79, v94, v95
v_mfma_f32_32x32x16_bf16 v[176:191], v[144:147], v[196:199], v[176:191]
ds_read_b32 v238, v236 offset:928
ds_read_b64_tr_b16 v[212:213], v239 offset:12544
ds_read_b64_tr_b16 v[214:215], v239 offset:13056
buffer_store_dwordx4 v[76:79], v237, s[32:35], s47 offen offset:3072 sc1
s_waitcnt lgkmcnt(5)
v_mfma_f32_32x32x16_bf16 v[160:175], v[148:151], v[200:203], v[160:175]
ds_read_b64_tr_b16 v[192:193], v239 offset:14336
ds_read_b64_tr_b16 v[194:195], v239 offset:14848
v_mul_f32 v96, v96, v248
v_mul_f32 v97, v97, v248
v_pk_mul_f32 v[98:99], v[98:99], v[248:249] op_sel_hi:[1,0]
v_pk_mul_f32 v[100:101], v[100:101], v[248:249] op_sel_hi:[1,0]
v_pk_mul_f32 v[102:103], v[102:103], v[248:249] op_sel_hi:[1,0]
v_cvt_pk_bf16_f32 v80, v96, v97
v_cvt_pk_bf16_f32 v81, v98, v99
v_cvt_pk_bf16_f32 v82, v100, v101
v_cvt_pk_bf16_f32 v83, v102, v103
v_mfma_f32_32x32x16_bf16 v[176:191], v[148:151], v[204:207], v[176:191]
ds_read_b64_tr_b16 v[196:197], v239 offset:14592
ds_read_b64_tr_b16 v[198:199], v239 offset:15104
s_add_u32 s47, s48, 49152
buffer_store_dwordx4 v[80:83], v237, s[32:35], s47 offen offset:0 sc1
s_waitcnt lgkmcnt(4)
v_mfma_f32_32x32x16_bf16 v[160:175], v[152:155], v[208:211], v[160:175]
v_cmp_ne_u32 vcc, 1, v238
s_nop 0
s_cbranch_vccnz L_spin29
L_back29:
v_add_u32 v240, 69632, v228
ds_read_b64_tr_b16 v[200:201], v240 offset:0
ds_read_b64_tr_b16 v[202:203], v240 offset:1024
v_pk_mul_f32 v[104:105], v[104:105], v[248:249] op_sel_hi:[1,0]
v_pk_mul_f32 v[106:107], v[106:107], v[248:249] op_sel_hi:[1,0]
v_pk_mul_f32 v[108:109], v[108:109], v[248:249] op_sel_hi:[1,0]
v_pk_mul_f32 v[110:111], v[110:111], v[248:249] op_sel_hi:[1,0]
v_cvt_pk_bf16_f32 v84, v104, v105
v_cvt_pk_bf16_f32 v85, v106, v107
v_cvt_pk_bf16_f32 v86, v108, v109
v_cvt_pk_bf16_f32 v87, v110, v111
v_mfma_f32_32x32x16_bf16 v[176:191], v[152:155], v[212:215], v[176:191]
ds_read_b64_tr_b16 v[204:205], v240 offset:256
ds_read_b64_tr_b16 v[206:207], v240 offset:1280
buffer_store_dwordx4 v[84:87], v237, s[32:35], s47 offen offset:1024 sc1
v_mul_f32 v112, v112, v248
v_mul_f32 v113, v113, v248
s_waitcnt lgkmcnt(4)
v_mfma_f32_32x32x16_bf16 v[160:175], v[156:159], v[192:195], v[160:175]
ds_read_b64_tr_b16 v[208:209], v240 offset:512
ds_read_b64_tr_b16 v[210:211], v240 offset:1536
v_mul_f32 v114, v114, v248
v_mul_f32 v115, v115, v248
v_pk_mul_f32 v[116:117], v[116:117], v[248:249] op_sel_hi:[1,0]
v_pk_mul_f32 v[118:119], v[118:119], v[248:249] op_sel_hi:[1,0]
v_cvt_pk_bf16_f32 v88, v112, v113
v_cvt_pk_bf16_f32 v89, v114, v115
v_cvt_pk_bf16_f32 v90, v116, v117
v_cvt_pk_bf16_f32 v91, v118, v119
v_mfma_f32_32x32x16_bf16 v[176:191], v[156:159], v[196:199], v[176:191]
global_load_lds_dword v235, s[96:97] offset:140
ds_read_b64_tr_b16 v[212:213], v240 offset:768
ds_read_b64_tr_b16 v[214:215], v240 offset:1792
buffer_store_dwordx4 v[88:91], v237, s[32:35], s47 offen offset:2048 sc1
s_waitcnt lgkmcnt(4)
v_mfma_f32_32x32x16_bf16 v[0:15], v[64:67], v[200:203], v[0:15]
ds_read_b64_tr_b16 v[192:193], v240 offset:4096
ds_read_b64_tr_b16 v[194:195], v240 offset:5120
v_mul_f32 v120, v120, v248
v_mul_f32 v121, v121, v248
v_pk_mul_f32 v[122:123], v[122:123], v[248:249] op_sel_hi:[1,0]
v_pk_mul_f32 v[124:125], v[124:125], v[248:249] op_sel_hi:[1,0]
v_pk_mul_f32 v[126:127], v[126:127], v[248:249] op_sel_hi:[1,0]
v_cvt_pk_bf16_f32 v92, v120, v121
v_cvt_pk_bf16_f32 v93, v122, v123
v_cvt_pk_bf16_f32 v94, v124, v125
v_cvt_pk_bf16_f32 v95, v126, v127
v_mfma_f32_32x32x16_bf16 v[16:31], v[64:67], v[204:207], v[16:31]
ds_read_b64_tr_b16 v[196:197], v240 offset:4352
ds_read_b64_tr_b16 v[198:199], v240 offset:5376
buffer_store_dwordx4 v[92:95], v237, s[32:35], s47 offen offset:3072 sc1
s_waitcnt lgkmcnt(4)
v_mfma_f32_32x32x16_bf16 v[32:47], v[64:67], v[208:211], v[32:47]
ds_read_b64_tr_b16 v[200:201], v240 offset:4608
ds_read_b64_tr_b16 v[202:203], v240 offset:5632
v_mfma_f32_32x32x16_bf16 v[48:63], v[64:67], v[212:215], v[48:63]
ds_read_b64_tr_b16 v[204:205], v240 offset:4864
ds_read_b64_tr_b16 v[206:207], v240 offset:5888
s_waitcnt lgkmcnt(4)
v_mfma_f32_32x32x16_bf16 v[0:15], v[68:71], v[192:195], v[0:15]
ds_read_b64_tr_b16 v[208:209], v240 offset:8192
ds_read_b64_tr_b16 v[210:211], v240 offset:9216
v_mfma_f32_32x32x16_bf16 v[16:31], v[68:71], v[196:199], v[16:31]
ds_read_b64_tr_b16 v[212:213], v240 offset:8448
ds_read_b64_tr_b16 v[214:215], v240 offset:9472
s_waitcnt lgkmcnt(4)
v_mfma_f32_32x32x16_bf16 v[32:47], v[68:71], v[200:203], v[32:47]
ds_read_b64_tr_b16 v[192:193], v240 offset:8704
ds_read_b64_tr_b16 v[194:195], v240 offset:9728
v_mfma_f32_32x32x16_bf16 v[48:63], v[68:71], v[204:207], v[48:63]
ds_read_b64_tr_b16 v[196:197], v240 offset:8960
ds_read_b64_tr_b16 v[198:199], v240 offset:9984
s_waitcnt lgkmcnt(4)
v_mfma_f32_32x32x16_bf16 v[0:15], v[72:75], v[208:211], v[0:15]
ds_read_b64_tr_b16 v[200:201], v240 offset:12288
ds_read_b64_tr_b16 v[202:203], v240 offset:13312
v_mfma_f32_32x32x16_bf16 v[16:31], v[72:75], v[212:215], v[16:31]
ds_read_b32 v238, v236 offset:960
ds_read_b64_tr_b16 v[204:205], v240 offset:12544
ds_read_b64_tr_b16 v[206:207], v240 offset:13568
s_waitcnt lgkmcnt(5)
v_mfma_f32_32x32x16_bf16 v[32:47], v[72:75], v[192:195], v[32:47]
ds_read_b64_tr_b16 v[208:209], v240 offset:12800
ds_read_b64_tr_b16 v[210:211], v240 offset:13824
v_mfma_f32_32x32x16_bf16 v[48:63], v[72:75], v[196:199], v[48:63]
ds_read_b64_tr_b16 v[212:213], v240 offset:13056
ds_read_b64_tr_b16 v[214:215], v240 offset:14080
s_waitcnt lgkmcnt(4)
v_mfma_f32_32x32x16_bf16 v[0:15], v[76:79], v[200:203], v[0:15]
v_cmp_ne_u32 vcc, 1, v238
s_nop 0
s_cbranch_vccnz L_spin30
L_back30:
v_add_u32 v241, 86016, v228
ds_read_b64_tr_b16 v[192:193], v241 offset:0
ds_read_b64_tr_b16 v[194:195], v241 offset:1024
v_mfma_f32_32x32x16_bf16 v[16:31], v[76:79], v[204:207], v[16:31]
ds_read_b64_tr_b16 v[196:197], v241 offset:256
ds_read_b64_tr_b16 v[198:199], v241 offset:1280
s_waitcnt lgkmcnt(4)
v_mfma_f32_32x32x16_bf16 v[32:47], v[76:79], v[208:211], v[32:47]
ds_read_b64_tr_b16 v[200:201], v241 offset:512
ds_read_b64_tr_b16 v[202:203], v241 offset:1536
v_mfma_f32_32x32x16_bf16 v[48:63], v[76:79], v[212:215], v[48:63]
global_load_lds_dword v235, s[96:97] offset:136
ds_read_b64_tr_b16 v[204:205], v241 offset:768
ds_read_b64_tr_b16 v[206:207], v241 offset:1792
s_waitcnt lgkmcnt(4)
v_mfma_f32_32x32x16_bf16 v[0:15], v[80:83], v[192:195], v[0:15]
ds_read_b64_tr_b16 v[208:209], v241 offset:4096
ds_read_b64_tr_b16 v[210:211], v241 offset:5120
v_mfma_f32_32x32x16_bf16 v[16:31], v[80:83], v[196:199], v[16:31]
ds_read_b64_tr_b16 v[212:213], v241 offset:4352
ds_read_b64_tr_b16 v[214:215], v241 offset:5376
s_waitcnt lgkmcnt(4)
v_mfma_f32_32x32x16_bf16 v[32:47], v[80:83], v[200:203], v[32:47]
ds_read_b64_tr_b16 v[192:193], v241 offset:4608
ds_read_b64_tr_b16 v[194:195], v241 offset:5632
v_mfma_f32_32x32x16_bf16 v[48:63], v[80:83], v[204:207], v[48:63]
ds_read_b64_tr_b16 v[196:197], v241 offset:4864
ds_read_b64_tr_b16 v[198:199], v241 offset:5888
s_waitcnt lgkmcnt(4)
v_mfma_f32_32x32x16_bf16 v[0:15], v[84:87], v[208:211], v[0:15]
ds_read_b64_tr_b16 v[200:201], v241 offset:8192
ds_read_b64_tr_b16 v[202:203], v241 offset:9216
v_mfma_f32_32x32x16_bf16 v[16:31], v[84:87], v[212:215], v[16:31]
ds_read_b64_tr_b16 v[204:205], v241 offset:8448
ds_read_b64_tr_b16 v[206:207], v241 offset:9472
s_waitcnt lgkmcnt(4)
v_mfma_f32_32x32x16_bf16 v[32:47], v[84:87], v[192:195], v[32:47]
ds_read_b64_tr_b16 v[208:209], v241 offset:8704
ds_read_b64_tr_b16 v[210:211], v241 offset:9728
v_mfma_f32_32x32x16_bf16 v[48:63], v[84:87], v[196:199], v[48:63]
ds_read_b64_tr_b16 v[212:213], v241 offset:8960
ds_read_b64_tr_b16 v[214:215], v241 offset:9984
s_waitcnt lgkmcnt(4)
v_mfma_f32_32x32x16_bf16 v[0:15], v[88:91], v[200:203], v[0:15]
ds_read_b64_tr_b16 v[192:193], v241 offset:12288
ds_read_b64_tr_b16 v[194:195], v241 offset:13312
v_mfma_f32_32x32x16_bf16 v[16:31], v[88:91], v[204:207], v[16:31]
ds_read_b32 v238, v236 offset:992
ds_read_b64_tr_b16 v[196:197], v241 offset:12544
ds_read_b64_tr_b16 v[198:199], v241 offset:13568
s_waitcnt lgkmcnt(5)
v_mfma_f32_32x32x16_bf16 v[32:47], v[88:91], v[208:211], v[32:47]
ds_read_b64_tr_b16 v[200:201], v241 offset:12800
ds_read_b64_tr_b16 v[202:203], v241 offset:13824
v_mfma_f32_32x32x16_bf16 v[48:63], v[88:91], v[212:215], v[48:63]
ds_read_b64_tr_b16 v[204:205], v241 offset:13056
ds_read_b64_tr_b16 v[206:207], v241 offset:14080
s_waitcnt lgkmcnt(4)
v_mfma_f32_32x32x16_bf16 v[0:15], v[92:95], v[192:195], v[0:15]
v_cmp_ne_u32 vcc, 1, v238
s_nop 0
s_cbranch_vccnz L_spin31
L_back31:
v_add_u32 v242, 102400, v229
ds_read_b64_tr_b16 v[208:209], v242 offset:0
ds_read_b64_tr_b16 v[210:211], v242 offset:512
v_mfma_f32_32x32x16_bf16 v[16:31], v[92:95], v[196:199], v[16:31]
ds_read_b64_tr_b16 v[212:213], v242 offset:256
ds_read_b64_tr_b16 v[214:215], v242 offset:768
s_waitcnt lgkmcnt(4)
v_mfma_f32_32x32x16_bf16 v[32:47], v[92:95], v[200:203], v[32:47]
ds_read_b64_tr_b16 v[192:193], v242 offset:2048
ds_read_b64_tr_b16 v[194:195], v242 offset:2560
v_mfma_f32_32x32x16_bf16 v[48:63], v[92:95], v[204:207], v[48:63]
global_load_lds_dword v235, s[96:97] offset:132
ds_read_b64_tr_b16 v[196:197], v242 offset:2304
ds_read_b64_tr_b16 v[198:199], v242 offset:2816
s_waitcnt lgkmcnt(4)
v_mfma_f32_32x32x16_bf16 v[160:175], v[64:67], v[208:211], v[160:175]
ds_read_b64_tr_b16 v[200:201], v242 offset:4096
ds_read_b64_tr_b16 v[202:203], v242 offset:4608
v_mfma_f32_32x32x16_bf16 v[176:191], v[64:67], v[212:215], v[176:191]
ds_read_b64_tr_b16 v[204:205], v242 offset:4352
ds_read_b64_tr_b16 v[206:207], v242 offset:4864
s_waitcnt lgkmcnt(4)
v_mfma_f32_32x32x16_bf16 v[160:175], v[68:71], v[192:195], v[160:175]
ds_read_b64_tr_b16 v[208:209], v242 offset:6144
ds_read_b64_tr_b16 v[210:211], v242 offset:6656
v_mfma_f32_32x32x16_bf16 v[176:191], v[68:71], v[196:199], v[176:191]
ds_read_b64_tr_b16 v[212:213], v242 offset:6400
ds_read_b64_tr_b16 v[214:215], v242 offset:6912
s_waitcnt lgkmcnt(4)
v_mfma_f32_32x32x16_bf16 v[160:175], v[72:75], v[200:203], v[160:175]
ds_read_b64_tr_b16 v[192:193], v242 offset:8192
ds_read_b64_tr_b16 v[194:195], v242 offset:8704
s_waitcnt vmcnt(2)
s_add_u32 s45, s56, 2
v_mov_b32 v254, s45
s_mov_b64 exec, 1
s_add_u32 s45, s49, 262144
buffer_store_dword v254, v235, s[32:35], s45 offen
buffer_store_dword v254, v235, s[32:35], s49 offen sc1
s_mov_b64 exec, -1
v_mfma_f32_32x32x16_bf16 v[176:191], v[72:75], v[204:207], v[176:191]
ds_read_b64_tr_b16 v[196:197], v242 offset:8448
ds_read_b64_tr_b16 v[198:199], v242 offset:8960
s_waitcnt lgkmcnt(4)
v_mfma_f32_32x32x16_bf16 v[160:175], v[76:79], v[208:211], v[160:175]
ds_read_b64_tr_b16 v[200:201], v242 offset:10240
ds_read_b64_tr_b16 v[202:203], v242 offset:10752
v_mfma_f32_32x32x16_bf16 v[176:191], v[76:79], v[212:215], v[176:191]
ds_read_b64_tr_b16 v[204:205], v242 offset:10496
ds_read_b64_tr_b16 v[206:207], v242 offset:11008
s_waitcnt lgkmcnt(4)
v_mfma_f32_32x32x16_bf16 v[160:175], v[80:83], v[192:195], v[160:175]
ds_read_b64_tr_b16 v[208:209], v242 offset:12288
ds_read_b64_tr_b16 v[210:211], v242 offset:12800
v_mfma_f32_32x32x16_bf16 v[176:191], v[80:83], v[196:199], v[176:191]
ds_read_b32 v238, v236 offset:1024
ds_read_b64_tr_b16 v[212:213], v242 offset:12544
ds_read_b64_tr_b16 v[214:215], v242 offset:13056
s_waitcnt lgkmcnt(5)
v_mfma_f32_32x32x16_bf16 v[160:175], v[84:87], v[200:203], v[160:175]
ds_read_b64_tr_b16 v[192:193], v242 offset:14336
ds_read_b64_tr_b16 v[194:195], v242 offset:14848
v_mfma_f32_32x32x16_bf16 v[176:191], v[84:87], v[204:207], v[176:191]
ds_read_b64_tr_b16 v[196:197], v242 offset:14592
ds_read_b64_tr_b16 v[198:199], v242 offset:15104
s_waitcnt lgkmcnt(4)
v_mfma_f32_32x32x16_bf16 v[160:175], v[88:91], v[208:211], v[160:175]
v_cmp_ne_u32 vcc, 1, v238
s_nop 0
s_cbranch_vccnz L_spin32
L_back32:
v_add_u32 v243, 118784, v228
ds_read_b64_tr_b16 v[200:201], v243 offset:0
ds_read_b64_tr_b16 v[202:203], v243 offset:1024
v_add_u32 v239, 4096, v237
ds_read_b128 v[64:67], v239 offset:0
v_mfma_f32_32x32x16_bf16 v[176:191], v[88:91], v[212:215], v[176:191]
ds_read_b64_tr_b16 v[204:205], v243 offset:256
ds_read_b64_tr_b16 v[206:207], v243 offset:1280
ds_read_b128 v[68:71], v239 offset:1024
s_waitcnt lgkmcnt(6)
v_mfma_f32_32x32x16_bf16 v[160:175], v[92:95], v[192:195], v[160:175]
ds_read_b64_tr_b16 v[208:209], v243 offset:512
ds_read_b64_tr_b16 v[210:211], v243 offset:1536
ds_read_b128 v[72:75], v239 offset:2048
v_mfma_f32_32x32x16_bf16 v[176:191], v[92:95], v[196:199], v[176:191]
global_load_lds_dword v235, s[96:97] offset:128
ds_read_b64_tr_b16 v[212:213], v243 offset:768
ds_read_b64_tr_b16 v[214:215], v243 offset:1792
ds_read_b128 v[76:79], v239 offset:3072
s_waitcnt lgkmcnt(7)
v_mfma_f32_32x32x16_bf16 v[0:15], v[64:67], v[200:203], v[0:15]
ds_read_b64_tr_b16 v[192:193], v243 offset:4096
ds_read_b64_tr_b16 v[194:195], v243 offset:5120
v_cvt_pk_bf16_f32 v96, v160, v161
v_cvt_pk_bf16_f32 v97, v162, v163
v_mfma_f32_32x32x16_bf16 v[16:31], v[64:67], v[204:207], v[16:31]
ds_read_b64_tr_b16 v[196:197], v243 offset:4352
ds_read_b64_tr_b16 v[198:199], v243 offset:5376
v_cvt_pk_bf16_f32 v98, v176, v177
v_cvt_pk_bf16_f32 v99, v178, v179
s_waitcnt lgkmcnt(5)
v_mfma_f32_32x32x16_bf16 v[32:47], v[64:67], v[208:211], v[32:47]
ds_read_b64_tr_b16 v[200:201], v243 offset:4608
ds_read_b64_tr_b16 v[202:203], v243 offset:5632
v_cvt_pk_bf16_f32 v100, v164, v165
v_cvt_pk_bf16_f32 v101, v166, v167
v_mfma_f32_32x32x16_bf16 v[48:63], v[64:67], v[212:215], v[48:63]
ds_read_b64_tr_b16 v[204:205], v243 offset:4864
ds_read_b64_tr_b16 v[206:207], v243 offset:5888
v_cvt_pk_bf16_f32 v102, v180, v181
v_cvt_pk_bf16_f32 v103, v182, v183
s_waitcnt lgkmcnt(4)
v_mfma_f32_32x32x16_bf16 v[0:15], v[68:71], v[192:195], v[0:15]
ds_read_b64_tr_b16 v[208:209], v243 offset:8192
ds_read_b64_tr_b16 v[210:211], v243 offset:9216
v_cvt_pk_bf16_f32 v104, v168, v169
v_cvt_pk_bf16_f32 v105, v170, v171
v_mfma_f32_32x32x16_bf16 v[16:31], v[68:71], v[196:199], v[16:31]
ds_read_b64_tr_b16 v[212:213], v243 offset:8448
ds_read_b64_tr_b16 v[214:215], v243 offset:9472
v_cvt_pk_bf16_f32 v106, v184, v185
v_cvt_pk_bf16_f32 v107, v186, v187
s_waitcnt lgkmcnt(4)
v_mfma_f32_32x32x16_bf16 v[32:47], v[68:71], v[200:203], v[32:47]
ds_read_b64_tr_b16 v[192:193], v243 offset:8704
ds_read_b64_tr_b16 v[194:195], v243 offset:9728
v_cvt_pk_bf16_f32 v108, v172, v173
v_cvt_pk_bf16_f32 v109, v174, v175
v_mfma_f32_32x32x16_bf16 v[48:63], v[68:71], v[204:207], v[48:63]
global_load_lds_dword v235, s[96:97] offset:124
ds_read_b64_tr_b16 v[196:197], v243 offset:8960
ds_read_b64_tr_b16 v[198:199], v243 offset:9984
v_cvt_pk_bf16_f32 v110, v188, v189
s_waitcnt lgkmcnt(4)
v_mfma_f32_32x32x16_bf16 v[0:15], v[72:75], v[208:211], v[0:15]
ds_read_b64_tr_b16 v[200:201], v243 offset:12288
ds_read_b64_tr_b16 v[202:203], v243 offset:13312
v_cvt_pk_bf16_f32 v111, v190, v191
v_mfma_f32_32x32x16_bf16 v[16:31], v[72:75], v[212:215], v[16:31]
ds_read_b32 v238, v236 offset:1088
ds_read_b64_tr_b16 v[204:205], v243 offset:12544
ds_read_b64_tr_b16 v[206:207], v243 offset:13568
s_waitcnt lgkmcnt(5)
v_mfma_f32_32x32x16_bf16 v[32:47], v[72:75], v[192:195], v[32:47]
ds_read_b64_tr_b16 v[208:209], v243 offset:12800
ds_read_b64_tr_b16 v[210:211], v243 offset:13824
v_mfma_f32_32x32x16_bf16 v[48:63], v[72:75], v[196:199], v[48:63]
ds_read_b64_tr_b16 v[212:213], v243 offset:13056
ds_read_b64_tr_b16 v[214:215], v243 offset:14080
s_waitcnt lgkmcnt(4)
v_mfma_f32_32x32x16_bf16 v[0:15], v[76:79], v[200:203], v[0:15]
v_cmp_ne_u32 vcc, 1, v238
s_nop 0
s_cbranch_vccnz L_spin34
L_back34:
v_add_u32 v240, 135168, v228
ds_read_b64_tr_b16 v[192:193], v240 offset:0
ds_read_b64_tr_b16 v[194:195], v240 offset:1024
v_add_u32 v241, 20480, v237
ds_read_b128 v[80:83], v241 offset:0
s_add_u32 s44, s51, 0
buffer_store_dwordx4 v[96:99], v234, s[32:35], s44 offen sc1
v_mfma_f32_32x32x16_bf16 v[16:31], v[76:79], v[204:207], v[16:31]
ds_read_b64_tr_b16 v[196:197], v240 offset:256
ds_read_b64_tr_b16 v[198:199], v240 offset:1280
ds_read_b128 v[84:87], v241 offset:1024
s_waitcnt lgkmcnt(6)
v_mfma_f32_32x32x16_bf16 v[32:47], v[76:79], v[208:211], v[32:47]
ds_read_b64_tr_b16 v[200:201], v240 offset:512
ds_read_b64_tr_b16 v[202:203], v240 offset:1536
ds_read_b128 v[88:91], v241 offset:2048
v_mfma_f32_32x32x16_bf16 v[48:63], v[76:79], v[212:215], v[48:63]
global_load_lds_dword v235, s[96:97] offset:120
ds_read_b64_tr_b16 v[204:205], v240 offset:768
ds_read_b64_tr_b16 v[206:207], v240 offset:1792
ds_read_b128 v[92:95], v241 offset:3072
s_add_u32 s44, s51, 65536
buffer_store_dwordx4 v[100:103], v234, s[32:35], s44 offen sc1
s_waitcnt lgkmcnt(7)
v_mfma_f32_32x32x16_bf16 v[0:15], v[80:83], v[192:195], v[0:15]
ds_read_b64_tr_b16 v[208:209], v240 offset:4096
ds_read_b64_tr_b16 v[210:211], v240 offset:5120
v_mfma_f32_32x32x16_bf16 v[16:31], v[80:83], v[196:199], v[16:31]
ds_read_b64_tr_b16 v[212:213], v240 offset:4352
ds_read_b64_tr_b16 v[214:215], v240 offset:5376
s_waitcnt lgkmcnt(5)
v_mfma_f32_32x32x16_bf16 v[32:47], v[80:83], v[200:203], v[32:47]
ds_read_b64_tr_b16 v[192:193], v240 offset:4608
ds_read_b64_tr_b16 v[194:195], v240 offset:5632
s_add_u32 s44, s51, 131072
buffer_store_dwordx4 v[104:107], v234, s[32:35], s44 offen sc1
v_mfma_f32_32x32x16_bf16 v[48:63], v[80:83], v[204:207], v[48:63]
ds_read_b64_tr_b16 v[196:197], v240 offset:4864
ds_read_b64_tr_b16 v[198:199], v240 offset:5888
s_waitcnt lgkmcnt(4)
v_mfma_f32_32x32x16_bf16 v[0:15], v[84:87], v[208:211], v[0:15]
ds_read_b64_tr_b16 v[200:201], v240 offset:8192
ds_read_b64_tr_b16 v[202:203], v240 offset:9216
v_mfma_f32_32x32x16_bf16 v[16:31], v[84:87], v[212:215], v[16:31]
ds_read_b64_tr_b16 v[204:205], v240 offset:8448
ds_read_b64_tr_b16 v[206:207], v240 offset:9472
s_add_u32 s44, s51, 196608
buffer_store_dwordx4 v[108:111], v234, s[32:35], s44 offen sc1
s_waitcnt lgkmcnt(4)
v_mfma_f32_32x32x16_bf16 v[32:47], v[84:87], v[192:195], v[32:47]
ds_read_b64_tr_b16 v[208:209], v240 offset:8704
ds_read_b64_tr_b16 v[210:211], v240 offset:9728
v_mfma_f32_32x32x16_bf16 v[48:63], v[84:87], v[196:199], v[48:63]
global_load_lds_dword v235, s[96:97] offset:116
ds_read_b64_tr_b16 v[212:213], v240 offset:8960
ds_read_b64_tr_b16 v[214:215], v240 offset:9984
s_waitcnt lgkmcnt(4)
v_mfma_f32_32x32x16_bf16 v[0:15], v[88:91], v[200:203], v[0:15]
ds_read_b64_tr_b16 v[192:193], v240 offset:12288
ds_read_b64_tr_b16 v[194:195], v240 offset:13312
v_mfma_f32_32x32x16_bf16 v[16:31], v[88:91], v[204:207], v[16:31]
ds_read_b32 v238, v236 offset:1152
ds_read_b64_tr_b16 v[196:197], v240 offset:12544
ds_read_b64_tr_b16 v[198:199], v240 offset:13568
s_waitcnt lgkmcnt(5)
v_mfma_f32_32x32x16_bf16 v[32:47], v[88:91], v[208:211], v[32:47]
ds_read_b64_tr_b16 v[200:201], v240 offset:12800
ds_read_b64_tr_b16 v[202:203], v240 offset:13824
v_mfma_f32_32x32x16_bf16 v[48:63], v[88:91], v[212:215], v[48:63]
ds_read_b64_tr_b16 v[204:205], v240 offset:13056
ds_read_b64_tr_b16 v[206:207], v240 offset:14080
s_waitcnt lgkmcnt(4)
v_mfma_f32_32x32x16_bf16 v[0:15], v[92:95], v[192:195], v[0:15]
v_cmp_ne_u32 vcc, 1, v238
s_nop 0
s_cbranch_vccnz L_spin36
L_back36:
v_add_u32 v242, 36864, v228
ds_read_b64_tr_b16 v[208:209], v242 offset:0
ds_read_b64_tr_b16 v[210:211], v242 offset:1024
v_add_u32 v243, 53248, v237
ds_read_b128 v[64:67], v243 offset:0
v_mfma_f32_32x32x16_bf16 v[16:31], v[92:95], v[196:199], v[16:31]
ds_read_b64_tr_b16 v[212:213], v242 offset:256
ds_read_b64_tr_b16 v[214:215], v242 offset:1280
ds_read_b128 v[68:71], v243 offset:1024
s_waitcnt lgkmcnt(6)
v_mfma_f32_32x32x16_bf16 v[32:47], v[92:95], v[200:203], v[32:47]
ds_read_b64_tr_b16 v[192:193], v242 offset:512
ds_read_b64_tr_b16 v[194:195], v242 offset:1536
ds_read_b128 v[72:75], v243 offset:2048
v_mfma_f32_32x32x16_bf16 v[48:63], v[92:95], v[204:207], v[48:63]
global_load_lds_dword v235, s[96:97] offset:112
ds_read_b64_tr_b16 v[196:197], v242 offset:768
ds_read_b64_tr_b16 v[198:199], v242 offset:1792
ds_read_b128 v[76:79], v243 offset:3072
s_waitcnt lgkmcnt(7)
v_mfma_f32_32x32x16_bf16 v[0:15], v[64:67], v[208:211], v[0:15]
ds_read_b64_tr_b16 v[200:201], v242 offset:4096
ds_read_b64_tr_b16 v[202:203], v242 offset:5120
v_mfma_f32_32x32x16_bf16 v[16:31], v[64:67], v[212:215], v[16:31]
ds_read_b64_tr_b16 v[204:205], v242 offset:4352
ds_read_b64_tr_b16 v[206:207], v242 offset:5376
s_waitcnt lgkmcnt(5)
v_mfma_f32_32x32x16_bf16 v[32:47], v[64:67], v[192:195], v[32:47]
ds_read_b64_tr_b16 v[208:209], v242 offset:4608
ds_read_b64_tr_b16 v[210:211], v242 offset:5632
v_mfma_f32_32x32x16_bf16 v[48:63], v[64:67], v[196:199], v[48:63]
ds_read_b64_tr_b16 v[212:213], v242 offset:4864
ds_read_b64_tr_b16 v[214:215], v242 offset:5888
s_waitcnt lgkmcnt(4)
v_mfma_f32_32x32x16_bf16 v[0:15], v[68:71], v[200:203], v[0:15]
ds_read_b64_tr_b16 v[192:193], v242 offset:8192
ds_read_b64_tr_b16 v[194:195], v242 offset:9216
v_mfma_f32_32x32x16_bf16 v[16:31], v[68:71], v[204:207], v[16:31]
ds_read_b64_tr_b16 v[196:197], v242 offset:8448
ds_read_b64_tr_b16 v[198:199], v242 offset:9472
s_waitcnt lgkmcnt(4)
v_mfma_f32_32x32x16_bf16 v[32:47], v[68:71], v[208:211], v[32:47]
ds_read_b64_tr_b16 v[200:201], v242 offset:8704
ds_read_b64_tr_b16 v[202:203], v242 offset:9728
v_mfma_f32_32x32x16_bf16 v[48:63], v[68:71], v[212:215], v[48:63]
global_load_lds_dword v235, s[96:97] offset:108
ds_read_b64_tr_b16 v[204:205], v242 offset:8960
ds_read_b64_tr_b16 v[206:207], v242 offset:9984
s_waitcnt lgkmcnt(4)
v_mfma_f32_32x32x16_bf16 v[0:15], v[72:75], v[192:195], v[0:15]
ds_read_b64_tr_b16 v[208:209], v242 offset:12288
ds_read_b64_tr_b16 v[210:211], v242 offset:13312
v_mfma_f32_32x32x16_bf16 v[16:31], v[72:75], v[196:199], v[16:31]
ds_read_b32 v238, v236 offset:1216
ds_read_b64_tr_b16 v[212:213], v242 offset:12544
ds_read_b64_tr_b16 v[214:215], v242 offset:13568
s_waitcnt lgkmcnt(5)
v_mfma_f32_32x32x16_bf16 v[32:47], v[72:75], v[200:203], v[32:47]
ds_read_b64_tr_b16 v[192:193], v242 offset:12800
ds_read_b64_tr_b16 v[194:195], v242 offset:13824
v_mfma_f32_32x32x16_bf16 v[48:63], v[72:75], v[204:207], v[48:63]
ds_read_b64_tr_b16 v[196:197], v242 offset:13056
ds_read_b64_tr_b16 v[198:199], v242 offset:14080
s_waitcnt lgkmcnt(4)
v_mfma_f32_32x32x16_bf16 v[0:15], v[76:79], v[208:211], v[0:15]
v_cmp_ne_u32 vcc, 1, v238
s_nop 0
s_cbranch_vccnz L_spin38
L_back38:
v_add_u32 v239, 69632, v228
ds_read_b64_tr_b16 v[200:201], v239 offset:0
ds_read_b64_tr_b16 v[202:203], v239 offset:1024
v_add_u32 v240, 86016, v237
ds_read_b128 v[80:83], v240 offset:0
v_mfma_f32_32x32x16_bf16 v[16:31], v[76:79], v[212:215], v[16:31]
ds_read_b64_tr_b16 v[204:205], v239 offset:256
ds_read_b64_tr_b16 v[206:207], v239 offset:1280
ds_read_b128 v[84:87], v240 offset:1024
s_waitcnt lgkmcnt(6)
v_mfma_f32_32x32x16_bf16 v[32:47], v[76:79], v[192:195], v[32:47]
ds_read_b64_tr_b16 v[208:209], v239 offset:512
ds_read_b64_tr_b16 v[210:211], v239 offset:1536
ds_read_b128 v[88:91], v240 offset:2048
v_mfma_f32_32x32x16_bf16 v[48:63], v[76:79], v[196:199], v[48:63]
global_load_lds_dword v235, s[96:97] offset:104
ds_read_b64_tr_b16 v[212:213], v239 offset:768
ds_read_b64_tr_b16 v[214:215], v239 offset:1792
ds_read_b128 v[92:95], v240 offset:3072
s_waitcnt lgkmcnt(7)
v_mfma_f32_32x32x16_bf16 v[0:15], v[80:83], v[200:203], v[0:15]
ds_read_b64_tr_b16 v[192:193], v239 offset:4096
ds_read_b64_tr_b16 v[194:195], v239 offset:5120
v_mfma_f32_32x32x16_bf16 v[16:31], v[80:83], v[204:207], v[16:31]
ds_read_b64_tr_b16 v[196:197], v239 offset:4352
ds_read_b64_tr_b16 v[198:199], v239 offset:5376
s_waitcnt lgkmcnt(5)
v_mfma_f32_32x32x16_bf16 v[32:47], v[80:83], v[208:211], v[32:47]
ds_read_b64_tr_b16 v[200:201], v239 offset:4608
ds_read_b64_tr_b16 v[202:203], v239 offset:5632
v_mfma_f32_32x32x16_bf16 v[48:63], v[80:83], v[212:215], v[48:63]
ds_read_b64_tr_b16 v[204:205], v239 offset:4864
ds_read_b64_tr_b16 v[206:207], v239 offset:5888
s_waitcnt lgkmcnt(4)
v_mfma_f32_32x32x16_bf16 v[0:15], v[84:87], v[192:195], v[0:15]
ds_read_b64_tr_b16 v[208:209], v239 offset:8192
ds_read_b64_tr_b16 v[210:211], v239 offset:9216
v_mfma_f32_32x32x16_bf16 v[16:31], v[84:87], v[196:199], v[16:31]
ds_read_b64_tr_b16 v[212:213], v239 offset:8448
ds_read_b64_tr_b16 v[214:215], v239 offset:9472
s_waitcnt lgkmcnt(4)
v_mfma_f32_32x32x16_bf16 v[32:47], v[84:87], v[200:203], v[32:47]
ds_read_b64_tr_b16 v[192:193], v239 offset:8704
ds_read_b64_tr_b16 v[194:195], v239 offset:9728
v_mfma_f32_32x32x16_bf16 v[48:63], v[84:87], v[204:207], v[48:63]
global_load_lds_dword v235, s[96:97] offset:100
ds_read_b64_tr_b16 v[196:197], v239 offset:8960
ds_read_b64_tr_b16 v[198:199], v239 offset:9984
s_waitcnt lgkmcnt(4)
v_mfma_f32_32x32x16_bf16 v[0:15], v[88:91], v[208:211], v[0:15]
ds_read_b64_tr_b16 v[200:201], v239 offset:12288
ds_read_b64_tr_b16 v[202:203], v239 offset:13312
v_mfma_f32_32x32x16_bf16 v[16:31], v[88:91], v[212:215], v[16:31]
ds_read_b32 v238, v236 offset:1280
ds_read_b64_tr_b16 v[204:205], v239 offset:12544
ds_read_b64_tr_b16 v[206:207], v239 offset:13568
s_waitcnt lgkmcnt(5)
v_mfma_f32_32x32x16_bf16 v[32:47], v[88:91], v[192:195], v[32:47]
ds_read_b64_tr_b16 v[208:209], v239 offset:12800
ds_read_b64_tr_b16 v[210:211], v239 offset:13824
v_mfma_f32_32x32x16_bf16 v[48:63], v[88:91], v[196:199], v[48:63]
ds_read_b64_tr_b16 v[212:213], v239 offset:13056
ds_read_b64_tr_b16 v[214:215], v239 offset:14080
s_waitcnt lgkmcnt(4)
v_mfma_f32_32x32x16_bf16 v[0:15], v[92:95], v[200:203], v[0:15]
v_cmp_ne_u32 vcc, 1, v238
s_nop 0
s_cbranch_vccnz L_spin40
L_back40:
v_add_u32 v241, 102400, v228
ds_read_b64_tr_b16 v[192:193], v241 offset:0
ds_read_b64_tr_b16 v[194:195], v241 offset:1024
v_add_u32 v242, 4096, v237
ds_read_b128 v[64:67], v242 offset:0
v_mfma_f32_32x32x16_bf16 v[16:31], v[92:95], v[204:207], v[16:31]
ds_read_b64_tr_b16 v[196:197], v241 offset:256
ds_read_b64_tr_b16 v[198:199], v241 offset:1280
ds_read_b128 v[68:71], v242 offset:1024
s_waitcnt lgkmcnt(6)
v_mfma_f32_32x32x16_bf16 v[32:47], v[92:95], v[208:211], v[32:47]
ds_read_b64_tr_b16 v[200:201], v241 offset:512
ds_read_b64_tr_b16 v[202:203], v241 offset:1536
ds_read_b128 v[72:75], v242 offset:2048
v_mfma_f32_32x32x16_bf16 v[48:63], v[92:95], v[212:215], v[48:63]
global_load_lds_dword v235, s[96:97] offset:96
ds_read_b64_tr_b16 v[204:205], v241 offset:768
ds_read_b64_tr_b16 v[206:207], v241 offset:1792
ds_read_b128 v[76:79], v242 offset:3072
s_waitcnt lgkmcnt(7)
v_mfma_f32_32x32x16_bf16 v[0:15], v[64:67], v[192:195], v[0:15]
ds_read_b64_tr_b16 v[208:209], v241 offset:4096
ds_read_b64_tr_b16 v[210:211], v241 offset:5120
s_waitcnt vmcnt(6)
s_add_u32 s45, s56, 3
v_mov_b32 v254, s45
s_mov_b64 exec, 1
buffer_store_dword v254, v235, s[32:35], s49 offen sc1
s_mov_b64 exec, -1
v_mfma_f32_32x32x16_bf16 v[16:31], v[64:67], v[196:199], v[16:31]
ds_read_b64_tr_b16 v[212:213], v241 offset:4352
ds_read_b64_tr_b16 v[214:215], v241 offset:5376
s_waitcnt lgkmcnt(5)
v_mfma_f32_32x32x16_bf16 v[32:47], v[64:67], v[200:203], v[32:47]
ds_read_b64_tr_b16 v[192:193], v241 offset:4608
ds_read_b64_tr_b16 v[194:195], v241 offset:5632
v_mfma_f32_32x32x16_bf16 v[48:63], v[64:67], v[204:207], v[48:63]
ds_read_b64_tr_b16 v[196:197], v241 offset:4864
ds_read_b64_tr_b16 v[198:199], v241 offset:5888
s_waitcnt lgkmcnt(4)
v_mfma_f32_32x32x16_bf16 v[0:15], v[68:71], v[208:211], v[0:15]
ds_read_b64_tr_b16 v[200:201], v241 offset:8192
ds_read_b64_tr_b16 v[202:203], v241 offset:9216
v_mfma_f32_32x32x16_bf16 v[16:31], v[68:71], v[212:215], v[16:31]
ds_read_b64_tr_b16 v[204:205], v241 offset:8448
ds_read_b64_tr_b16 v[206:207], v241 offset:9472
s_waitcnt lgkmcnt(4)
v_mfma_f32_32x32x16_bf16 v[32:47], v[68:71], v[192:195], v[32:47]
ds_read_b64_tr_b16 v[208:209], v241 offset:8704
ds_read_b64_tr_b16 v[210:211], v241 offset:9728
v_mfma_f32_32x32x16_bf16 v[48:63], v[68:71], v[196:199], v[48:63]
global_load_lds_dword v235, s[96:97] offset:92
ds_read_b64_tr_b16 v[212:213], v241 offset:8960
ds_read_b64_tr_b16 v[214:215], v241 offset:9984
s_waitcnt lgkmcnt(4)
v_mfma_f32_32x32x16_bf16 v[0:15], v[72:75], v[200:203], v[0:15]
ds_read_b64_tr_b16 v[192:193], v241 offset:12288
ds_read_b64_tr_b16 v[194:195], v241 offset:13312
v_mfma_f32_32x32x16_bf16 v[16:31], v[72:75], v[204:207], v[16:31]
ds_read_b32 v238, v236 offset:1344
ds_read_b64_tr_b16 v[196:197], v241 offset:12544
ds_read_b64_tr_b16 v[198:199], v241 offset:13568
s_waitcnt lgkmcnt(5)
v_mfma_f32_32x32x16_bf16 v[32:47], v[72:75], v[208:211], v[32:47]
ds_read_b64_tr_b16 v[200:201], v241 offset:12800
ds_read_b64_tr_b16 v[202:203], v241 offset:13824
v_mbcnt_lo_u32_b32 v251, -1, 0
v_and_b32 v251, 3, v251
v_mfma_f32_32x32x16_bf16 v[48:63], v[72:75], v[212:215], v[48:63]
ds_read_b64_tr_b16 v[204:205], v241 offset:13056
ds_read_b64_tr_b16 v[206:207], v241 offset:14080
v_lshlrev_b32 v251, 11, v251
v_xor_b32 v251, s49, v251
s_waitcnt lgkmcnt(4)
v_mfma_f32_32x32x16_bf16 v[0:15], v[76:79], v[192:195], v[0:15]
v_cmp_ne_u32 vcc, 1, v238
s_nop 0
s_cbranch_vccnz L_spin42
L_back42:
v_add_u32 v243, 118784, v228
ds_read_b64_tr_b16 v[208:209], v243 offset:0
ds_read_b64_tr_b16 v[210:211], v243 offset:1024
v_add_u32 v239, 20480, v237
ds_read_b128 v[80:83], v239 offset:0
v_mfma_f32_32x32x16_bf16 v[16:31], v[76:79], v[196:199], v[16:31]
ds_read_b64_tr_b16 v[212:213], v243 offset:256
ds_read_b64_tr_b16 v[214:215], v243 offset:1280
ds_read_b128 v[84:87], v239 offset:1024
buffer_load_dword v252, v251, s[32:35], 0 offen offset:4 sc1
s_waitcnt lgkmcnt(6)
v_mfma_f32_32x32x16_bf16 v[32:47], v[76:79], v[200:203], v[32:47]
ds_read_b64_tr_b16 v[192:193], v243 offset:512
ds_read_b64_tr_b16 v[194:195], v243 offset:1536
ds_read_b128 v[88:91], v239 offset:2048
v_mfma_f32_32x32x16_bf16 v[48:63], v[76:79], v[204:207], v[48:63]
global_load_lds_dword v235, s[96:97] offset:88
ds_read_b64_tr_b16 v[196:197], v243 offset:768
ds_read_b64_tr_b16 v[198:199], v243 offset:1792
ds_read_b128 v[92:95], v239 offset:3072
s_waitcnt lgkmcnt(7)
v_mfma_f32_32x32x16_bf16 v[0:15], v[80:83], v[208:211], v[0:15]
ds_read_b64_tr_b16 v[200:201], v243 offset:4096
ds_read_b64_tr_b16 v[202:203], v243 offset:5120
v_mfma_f32_32x32x16_bf16 v[16:31], v[80:83], v[212:215], v[16:31]
ds_read_b64_tr_b16 v[204:205], v243 offset:4352
ds_read_b64_tr_b16 v[206:207], v243 offset:5376
s_waitcnt lgkmcnt(5)
v_mfma_f32_32x32x16_bf16 v[32:47], v[80:83], v[192:195], v[32:47]
ds_read_b64_tr_b16 v[208:209], v243 offset:4608
ds_read_b64_tr_b16 v[210:211], v243 offset:5632
v_mfma_f32_32x32x16_bf16 v[48:63], v[80:83], v[196:199], v[48:63]
ds_read_b64_tr_b16 v[212:213], v243 offset:4864
ds_read_b64_tr_b16 v[214:215], v243 offset:5888
s_waitcnt lgkmcnt(4)
v_mfma_f32_32x32x16_bf16 v[0:15], v[84:87], v[200:203], v[0:15]
ds_read_b64_tr_b16 v[192:193], v243 offset:8192
ds_read_b64_tr_b16 v[194:195], v243 offset:9216
v_mfma_f32_32x32x16_bf16 v[16:31], v[84:87], v[204:207], v[16:31]
ds_read_b64_tr_b16 v[196:197], v243 offset:8448
ds_read_b64_tr_b16 v[198:199], v243 offset:9472
s_waitcnt lgkmcnt(4)
v_mfma_f32_32x32x16_bf16 v[32:47], v[84:87], v[208:211], v[32:47]
ds_read_b64_tr_b16 v[200:201], v243 offset:8704
ds_read_b64_tr_b16 v[202:203], v243 offset:9728
v_mfma_f32_32x32x16_bf16 v[48:63], v[84:87], v[212:215], v[48:63]
global_load_lds_dword v235, s[96:97] offset:84
ds_read_b64_tr_b16 v[204:205], v243 offset:8960
ds_read_b64_tr_b16 v[206:207], v243 offset:9984
s_waitcnt lgkmcnt(4)
v_mfma_f32_32x32x16_bf16 v[0:15], v[88:91], v[192:195], v[0:15]
ds_read_b64_tr_b16 v[208:209], v243 offset:12288
ds_read_b64_tr_b16 v[210:211], v243 offset:13312
v_mfma_f32_32x32x16_bf16 v[16:31], v[88:91], v[196:199], v[16:31]
ds_read_b32 v238, v236 offset:1408
ds_read_b64_tr_b16 v[212:213], v243 offset:12544
ds_read_b64_tr_b16 v[214:215], v243 offset:13568
s_waitcnt lgkmcnt(5)
v_mfma_f32_32x32x16_bf16 v[32:47], v[88:91], v[200:203], v[32:47]
ds_read_b64_tr_b16 v[192:193], v243 offset:12800
ds_read_b64_tr_b16 v[194:195], v243 offset:13824
v_mfma_f32_32x32x16_bf16 v[48:63], v[88:91], v[204:207], v[48:63]
ds_read_b64_tr_b16 v[196:197], v243 offset:13056
ds_read_b64_tr_b16 v[198:199], v243 offset:14080
s_waitcnt lgkmcnt(4)
v_mfma_f32_32x32x16_bf16 v[0:15], v[92:95], v[208:211], v[0:15]
v_cmp_ne_u32 vcc, 1, v238
s_nop 0
s_cbranch_vccnz L_spin44
L_back44:
v_add_u32 v240, 135168, v228
ds_read_b64_tr_b16 v[200:201], v240 offset:0
ds_read_b64_tr_b16 v[202:203], v240 offset:1024
v_add_u32 v241, 53248, v237
ds_read_b128 v[64:67], v241 offset:0
v_mfma_f32_32x32x16_bf16 v[16:31], v[92:95], v[212:215], v[16:31]
ds_read_b64_tr_b16 v[204:205], v240 offset:256
ds_read_b64_tr_b16 v[206:207], v240 offset:1280
ds_read_b128 v[68:71], v241 offset:1024
s_waitcnt lgkmcnt(6)
v_mfma_f32_32x32x16_bf16 v[32:47], v[92:95], v[192:195], v[32:47]
ds_read_b64_tr_b16 v[208:209], v240 offset:512
ds_read_b64_tr_b16 v[210:211], v240 offset:1536
ds_read_b128 v[72:75], v241 offset:2048
v_mfma_f32_32x32x16_bf16 v[48:63], v[92:95], v[196:199], v[48:63]
global_load_lds_dword v235, s[96:97] offset:80
ds_read_b64_tr_b16 v[212:213], v240 offset:768
ds_read_b64_tr_b16 v[214:215], v240 offset:1792
ds_read_b128 v[76:79], v241 offset:3072
s_waitcnt lgkmcnt(7)
v_mfma_f32_32x32x16_bf16 v[0:15], v[64:67], v[200:203], v[0:15]
ds_read_b64_tr_b16 v[192:193], v240 offset:4096
ds_read_b64_tr_b16 v[194:195], v240 offset:5120
v_mfma_f32_32x32x16_bf16 v[16:31], v[64:67], v[204:207], v[16:31]
ds_read_b64_tr_b16 v[196:197], v240 offset:4352
ds_read_b64_tr_b16 v[198:199], v240 offset:5376
s_waitcnt lgkmcnt(5)
v_mfma_f32_32x32x16_bf16 v[32:47], v[64:67], v[208:211], v[32:47]
ds_read_b64_tr_b16 v[200:201], v240 offset:4608
ds_read_b64_tr_b16 v[202:203], v240 offset:5632
v_mfma_f32_32x32x16_bf16 v[48:63], v[64:67], v[212:215], v[48:63]
ds_read_b64_tr_b16 v[204:205], v240 offset:4864
ds_read_b64_tr_b16 v[206:207], v240 offset:5888
s_waitcnt lgkmcnt(4)
v_mfma_f32_32x32x16_bf16 v[0:15], v[68:71], v[192:195], v[0:15]
ds_read_b64_tr_b16 v[208:209], v240 offset:8192
ds_read_b64_tr_b16 v[210:211], v240 offset:9216
v_mfma_f32_32x32x16_bf16 v[16:31], v[68:71], v[196:199], v[16:31]
ds_read_b64_tr_b16 v[212:213], v240 offset:8448
ds_read_b64_tr_b16 v[214:215], v240 offset:9472
s_waitcnt lgkmcnt(4)
v_mfma_f32_32x32x16_bf16 v[32:47], v[68:71], v[200:203], v[32:47]
ds_read_b64_tr_b16 v[192:193], v240 offset:8704
ds_read_b64_tr_b16 v[194:195], v240 offset:9728
v_mfma_f32_32x32x16_bf16 v[48:63], v[68:71], v[204:207], v[48:63]
global_load_lds_dword v235, s[96:97] offset:76
ds_read_b64_tr_b16 v[196:197], v240 offset:8960
ds_read_b64_tr_b16 v[198:199], v240 offset:9984
s_waitcnt lgkmcnt(4)
v_mfma_f32_32x32x16_bf16 v[0:15], v[72:75], v[208:211], v[0:15]
ds_read_b64_tr_b16 v[200:201], v240 offset:12288
ds_read_b64_tr_b16 v[202:203], v240 offset:13312
v_mfma_f32_32x32x16_bf16 v[16:31], v[72:75], v[212:215], v[16:31]
ds_read_b32 v238, v236 offset:1472
ds_read_b64_tr_b16 v[204:205], v240 offset:12544
ds_read_b64_tr_b16 v[206:207], v240 offset:13568
s_waitcnt lgkmcnt(5)
v_mfma_f32_32x32x16_bf16 v[32:47], v[72:75], v[192:195], v[32:47]
ds_read_b64_tr_b16 v[208:209], v240 offset:12800
ds_read_b64_tr_b16 v[210:211], v240 offset:13824
v_mfma_f32_32x32x16_bf16 v[48:63], v[72:75], v[196:199], v[48:63]
ds_read_b64_tr_b16 v[212:213], v240 offset:13056
ds_read_b64_tr_b16 v[214:215], v240 offset:14080
s_waitcnt lgkmcnt(4)
v_mfma_f32_32x32x16_bf16 v[0:15], v[76:79], v[200:203], v[0:15]
v_cmp_ne_u32 vcc, 1, v238
s_nop 0
s_cbranch_vccnz L_spin46
L_back46:
v_add_u32 v242, 86016, v228
ds_read_b64_tr_b16 v[192:193], v242 offset:0
ds_read_b64_tr_b16 v[194:195], v242 offset:1024
v_add_u32 v243, 69632, v237
ds_read_b128 v[80:83], v243 offset:0
v_mfma_f32_32x32x16_bf16 v[16:31], v[76:79], v[204:207], v[16:31]
ds_read_b64_tr_b16 v[196:197], v242 offset:256
ds_read_b64_tr_b16 v[198:199], v242 offset:1280
ds_read_b128 v[84:87], v243 offset:1024
s_waitcnt lgkmcnt(6)
v_mfma_f32_32x32x16_bf16 v[32:47], v[76:79], v[208:211], v[32:47]
ds_read_b64_tr_b16 v[200:201], v242 offset:512
ds_read_b64_tr_b16 v[202:203], v242 offset:1536
ds_read_b128 v[88:91], v243 offset:2048
v_mfma_f32_32x32x16_bf16 v[48:63], v[76:79], v[212:215], v[48:63]
global_load_lds_dword v235, s[96:97] offset:72
ds_read_b64_tr_b16 v[204:205], v242 offset:768
ds_read_b64_tr_b16 v[206:207], v242 offset:1792
ds_read_b128 v[92:95], v243 offset:3072
s_waitcnt lgkmcnt(7)
v_mfma_f32_32x32x16_bf16 v[0:15], v[80:83], v[192:195], v[0:15]
ds_read_b64_tr_b16 v[208:209], v242 offset:4096
ds_read_b64_tr_b16 v[210:211], v242 offset:5120
v_mfma_f32_32x32x16_bf16 v[16:31], v[80:83], v[196:199], v[16:31]
ds_read_b64_tr_b16 v[212:213], v242 offset:4352
ds_read_b64_tr_b16 v[214:215], v242 offset:5376
s_waitcnt lgkmcnt(5)
v_mfma_f32_32x32x16_bf16 v[32:47], v[80:83], v[200:203], v[32:47]
ds_read_b64_tr_b16 v[192:193], v242 offset:4608
ds_read_b64_tr_b16 v[194:195], v242 offset:5632
s_add_u32 s45, s56, 1
s_waitcnt vmcnt(5)
v_subrev_u32 v252, s45, v252
v_cmp_lt_u32 vcc, 6, v252
s_nop 0
s_cbranch_vccnz L_ownspin
L_ownok:
s_lshl_b32 s11, s56, 16
s_sub_u32 s11, 0, s11
v_mfma_f32_32x32x16_bf16 v[48:63], v[80:83], v[204:207], v[48:63]
ds_read_b64_tr_b16 v[196:197], v242 offset:4864
ds_read_b64_tr_b16 v[198:199], v242 offset:5888
s_waitcnt lgkmcnt(4)
v_mfma_f32_32x32x16_bf16 v[0:15], v[84:87], v[208:211], v[0:15]
ds_read_b64_tr_b16 v[200:201], v242 offset:8192
ds_read_b64_tr_b16 v[202:203], v242 offset:9216
v_mfma_f32_32x32x16_bf16 v[16:31], v[84:87], v[212:215], v[16:31]
ds_read_b64_tr_b16 v[204:205], v242 offset:8448
ds_read_b64_tr_b16 v[206:207], v242 offset:9472
s_waitcnt lgkmcnt(4)
v_mfma_f32_32x32x16_bf16 v[32:47], v[84:87], v[192:195], v[32:47]
ds_read_b64_tr_b16 v[208:209], v242 offset:8704
ds_read_b64_tr_b16 v[210:211], v242 offset:9728
v_mfma_f32_32x32x16_bf16 v[48:63], v[84:87], v[196:199], v[48:63]
global_load_lds_dword v235, s[96:97] offset:68
ds_read_b64_tr_b16 v[212:213], v242 offset:8960
ds_read_b64_tr_b16 v[214:215], v242 offset:9984
s_waitcnt lgkmcnt(4)
v_mfma_f32_32x32x16_bf16 v[0:15], v[88:91], v[200:203], v[0:15]
ds_read_b64_tr_b16 v[192:193], v242 offset:12288
ds_read_b64_tr_b16 v[194:195], v242 offset:13312
v_mfma_f32_32x32x16_bf16 v[16:31], v[88:91], v[204:207], v[16:31]
ds_read_b32 v238, v236 offset:1536
ds_read_b64_tr_b16 v[196:197], v242 offset:12544
ds_read_b64_tr_b16 v[198:199], v242 offset:13568
s_waitcnt lgkmcnt(5)
v_mfma_f32_32x32x16_bf16 v[32:47], v[88:91], v[208:211], v[32:47]
ds_read_b64_tr_b16 v[200:201], v242 offset:12800
ds_read_b64_tr_b16 v[202:203], v242 offset:13824
v_mfma_f32_32x32x16_bf16 v[48:63], v[88:91], v[212:215], v[48:63]
ds_read_b64_tr_b16 v[204:205], v242 offset:13056
ds_read_b64_tr_b16 v[206:207], v242 offset:14080
s_waitcnt lgkmcnt(4)
v_mfma_f32_32x32x16_bf16 v[0:15], v[92:95], v[192:195], v[0:15]
v_cmp_ne_u32 vcc, 1, v238
s_nop 0
s_cbranch_vccnz L_spin48
L_back48:
v_add_u32 v239, 102400, v229
ds_read_b64_tr_b16 v[208:209], v239 offset:0
ds_read_b64_tr_b16 v[210:211], v239 offset:512
v_add_u32 v240, 36864, v237
ds_read_b128 v[96:99], v240 offset:0
v_mfma_f32_32x32x16_bf16 v[16:31], v[92:95], v[196:199], v[16:31]
ds_read_b32 v238, v236 offset:1568
ds_read_b64_tr_b16 v[212:213], v239 offset:2048
ds_read_b64_tr_b16 v[214:215], v239 offset:2560
ds_read_b128 v[100:103], v240 offset:1024
s_waitcnt lgkmcnt(7)
v_mfma_f32_32x32x16_bf16 v[32:47], v[92:95], v[200:203], v[32:47]
ds_read_b64_tr_b16 v[192:193], v239 offset:4096
ds_read_b64_tr_b16 v[194:195], v239 offset:4608
ds_read_b128 v[104:107], v240 offset:2048
v_mfma_f32_32x32x16_bf16 v[48:63], v[92:95], v[204:207], v[48:63]
global_load_lds_dword v235, s[96:97] offset:64
ds_read_b64_tr_b16 v[196:197], v239 offset:6144
ds_read_b64_tr_b16 v[198:199], v239 offset:6656
ds_read_b128 v[108:111], v240 offset:3072
s_waitcnt lgkmcnt(6)
v_mfma_f32_32x32x16_bf16 v[0:15], v[96:99], v[208:211], v[0:15]
v_cmp_ne_u32 vcc, 1, v238
s_nop 0
s_cbranch_vccnz L_spin49
L_back49:
ds_read_b64_tr_b16 v[200:201], v239 offset:8192
ds_read_b64_tr_b16 v[202:203], v239 offset:8704
v_add_u32 v241, 4096, v237
ds_read_b128 v[112:115], v241 offset:0
v_mfma_f32_32x32x16_bf16 v[0:15], v[100:103], v[212:215], v[0:15]
ds_read_b32 v238, v236 offset:1600
ds_read_b64_tr_b16 v[204:205], v239 offset:10240
ds_read_b64_tr_b16 v[206:207], v239 offset:10752
ds_read_b128 v[116:119], v241 offset:1024
s_waitcnt lgkmcnt(7)
v_mfma_f32_32x32x16_bf16 v[0:15], v[104:107], v[192:195], v[0:15]
ds_read_b64_tr_b16 v[208:209], v239 offset:12288
ds_read_b64_tr_b16 v[210:211], v239 offset:12800
ds_read_b128 v[120:123], v241 offset:2048
v_mfma_f32_32x32x16_bf16 v[0:15], v[108:111], v[196:199], v[0:15]
global_load_lds_dword v235, s[96:97] offset:60
ds_read_b64_tr_b16 v[212:213], v239 offset:14336
ds_read_b64_tr_b16 v[214:215], v239 offset:14848
ds_read_b128 v[124:127], v241 offset:3072
s_waitcnt lgkmcnt(6)
v_mfma_f32_32x32x16_bf16 v[0:15], v[112:115], v[200:203], v[0:15]
v_cmp_ne_u32 vcc, 1, v238
s_nop 0
s_cbranch_vccnz L_spin50
L_back50:
v_add_u32 v242, 118784, v229
ds_read_b64_tr_b16 v[192:193], v242 offset:0
ds_read_b64_tr_b16 v[194:195], v242 offset:512
v_add_u32 v243, 20480, v237
ds_read_b128 v[128:131], v243 offset:0
v_mfma_f32_32x32x16_bf16 v[0:15], v[116:119], v[204:207], v[0:15]
ds_read_b32 v238, v236 offset:1632
ds_read_b64_tr_b16 v[196:197], v242 offset:2048
ds_read_b64_tr_b16 v[198:199], v242 offset:2560
ds_read_b128 v[132:135], v243 offset:1024
s_waitcnt lgkmcnt(7)
v_mfma_f32_32x32x16_bf16 v[0:15], v[120:123], v[208:211], v[0:15]
ds_read_b64_tr_b16 v[200:201], v242 offset:4096
ds_read_b64_tr_b16 v[202:203], v242 offset:4608
ds_read_b128 v[136:139], v243 offset:2048
v_mfma_f32_32x32x16_bf16 v[0:15], v[124:127], v[212:215], v[0:15]
ds_read_b64_tr_b16 v[204:205], v242 offset:6144
ds_read_b64_tr_b16 v[206:207], v242 offset:6656
ds_read_b128 v[140:143], v243 offset:3072
s_waitcnt lgkmcnt(6)
v_mfma_f32_32x32x16_bf16 v[0:15], v[128:131], v[192:195], v[0:15]
v_cmp_ne_u32 vcc, 1, v238
s_nop 0
s_cbranch_vccnz L_spin51
L_back51:
ds_read_b64_tr_b16 v[208:209], v242 offset:8192
ds_read_b64_tr_b16 v[210:211], v242 offset:8704
v_add_u32 v240, 53248, v237
ds_read_b128 v[144:147], v240 offset:0
v_mfma_f32_32x32x16_bf16 v[0:15], v[132:135], v[196:199], v[0:15]
ds_read_b64_tr_b16 v[212:213], v242 offset:10240
ds_read_b64_tr_b16 v[214:215], v242 offset:10752
ds_read_b128 v[148:151], v240 offset:1024
s_waitcnt lgkmcnt(6)
v_mfma_f32_32x32x16_bf16 v[0:15], v[136:139], v[200:203], v[0:15]
ds_read_b64_tr_b16 v[192:193], v242 offset:12288
ds_read_b64_tr_b16 v[194:195], v242 offset:12800
ds_read_b128 v[152:155], v240 offset:2048
v_mfma_f32_32x32x16_bf16 v[0:15], v[140:143], v[204:207], v[0:15]
ds_read_b64_tr_b16 v[196:197], v242 offset:14336
ds_read_b64_tr_b16 v[198:199], v242 offset:14848
ds_read_b128 v[156:159], v240 offset:3072
s_waitcnt lgkmcnt(6)
v_mfma_f32_32x32x16_bf16 v[0:15], v[144:147], v[208:211], v[0:15]
ds_read_b64_tr_b16 v[200:201], v239 offset:256
ds_read_b64_tr_b16 v[202:203], v239 offset:768
v_mfma_f32_32x32x16_bf16 v[0:15], v[148:151], v[212:215], v[0:15]
ds_read_b64_tr_b16 v[204:205], v239 offset:2304
ds_read_b64_tr_b16 v[206:207], v239 offset:2816
s_waitcnt lgkmcnt(4)
v_mfma_f32_32x32x16_bf16 v[0:15], v[152:155], v[192:195], v[0:15]
ds_read_b64_tr_b16 v[208:209], v239 offset:4352
ds_read_b64_tr_b16 v[210:211], v239 offset:4864
v_mfma_f32_32x32x16_bf16 v[0:15], v[156:159], v[196:199], v[0:15]
ds_read_b64_tr_b16 v[212:213], v239 offset:6400
ds_read_b64_tr_b16 v[214:215], v239 offset:6912
s_waitcnt lgkmcnt(4)
v_mfma_f32_32x32x16_bf16 v[16:31], v[96:99], v[200:203], v[16:31]
ds_read_b64_tr_b16 v[192:193], v239 offset:8448
ds_read_b64_tr_b16 v[194:195], v239 offset:8960
v_mfma_f32_32x32x16_bf16 v[16:31], v[100:103], v[204:207], v[16:31]
ds_read_b64_tr_b16 v[196:197], v239 offset:10496
ds_read_b64_tr_b16 v[198:199], v239 offset:11008
s_nop 2
v_cvt_pk_bf16_f32 v160, v0, v1
v_pk_add_u16 v160, s56, v160
s_waitcnt lgkmcnt(4)
v_mfma_f32_32x32x16_bf16 v[16:31], v[104:107], v[208:211], v[16:31]
ds_read_b64_tr_b16 v[200:201], v239 offset:12544
ds_read_b64_tr_b16 v[202:203], v239 offset:13056
s_xor_b32 s46, s5, 3
s_lshl_b32 s46, s46, 17
s_add_u32 s46, s46, s50
v_mfma_f32_32x32x16_bf16 v[16:31], v[108:111], v[212:215], v[16:31]
ds_read_b64_tr_b16 v[204:205], v239 offset:14592
ds_read_b64_tr_b16 v[206:207], v239 offset:15104
v_cvt_pk_bf16_f32 v161, v2, v3
v_pk_add_u16 v161, s56, v161
s_waitcnt lgkmcnt(4)
v_mfma_f32_32x32x16_bf16 v[16:31], v[112:115], v[192:195], v[16:31]
ds_read_b64_tr_b16 v[208:209], v242 offset:256
ds_read_b64_tr_b16 v[210:211], v242 offset:768
v_cvt_pk_bf16_f32 v162, v4, v5
v_pk_add_u16 v162, s56, v162
v_mfma_f32_32x32x16_bf16 v[16:31], v[116:119], v[196:199], v[16:31]
ds_read_b64_tr_b16 v[212:213], v242 offset:2304
ds_read_b64_tr_b16 v[214:215], v242 offset:2816
v_cvt_pk_bf16_f32 v163, v6, v7
v_pk_add_u16 v163, s56, v163
s_waitcnt lgkmcnt(4)
v_mfma_f32_32x32x16_bf16 v[16:31], v[120:123], v[200:203], v[16:31]
ds_read_b64_tr_b16 v[192:193], v242 offset:4352
ds_read_b64_tr_b16 v[194:195], v242 offset:4864
s_add_u32 s44, s46, 0
buffer_store_dwordx4 v[160:163], v234, s[32:35], s44 offen sc1
v_mfma_f32_32x32x16_bf16 v[16:31], v[124:127], v[204:207], v[16:31]
ds_read_b64_tr_b16 v[196:197], v242 offset:6400
ds_read_b64_tr_b16 v[198:199], v242 offset:6912
v_cvt_pk_bf16_f32 v164, v8, v9
v_pk_add_u16 v164, s56, v164
s_waitcnt lgkmcnt(4)
v_mfma_f32_32x32x16_bf16 v[16:31], v[128:131], v[208:211], v[16:31]
ds_read_b64_tr_b16 v[200:201], v242 offset:8448
ds_read_b64_tr_b16 v[202:203], v242 offset:8960
v_cvt_pk_bf16_f32 v165, v10, v11
v_pk_add_u16 v165, s56, v165
v_mfma_f32_32x32x16_bf16 v[16:31], v[132:135], v[212:215], v[16:31]
ds_read_b32 v238, v236 offset:1696
ds_read_b64_tr_b16 v[204:205], v242 offset:10496
ds_read_b64_tr_b16 v[206:207], v242 offset:11008
v_cvt_pk_bf16_f32 v166, v12, v13
s_waitcnt lgkmcnt(5)
v_mfma_f32_32x32x16_bf16 v[16:31], v[136:139], v[192:195], v[16:31]
ds_read_b64_tr_b16 v[208:209], v242 offset:12544
ds_read_b64_tr_b16 v[210:211], v242 offset:13056
v_pk_add_u16 v166, s56, v166
v_cvt_pk_bf16_f32 v167, v14, v15
v_mfma_f32_32x32x16_bf16 v[16:31], v[140:143], v[196:199], v[16:31]
ds_read_b64_tr_b16 v[212:213], v242 offset:14592
ds_read_b64_tr_b16 v[214:215], v242 offset:15104
v_pk_add_u16 v167, s56, v167
s_add_u32 s44, s46, 4096
buffer_store_dwordx4 v[164:167], v234, s[32:35], s44 offen sc1
s_waitcnt lgkmcnt(4)
v_mfma_f32_32x32x16_bf16 v[16:31], v[144:147], v[200:203], v[16:31]
v_cmp_ne_u32 vcc, 1, v238
s_nop 0
s_cbranch_vccnz L_spin53
L_back53:
v_add_u32 v241, 135168, v229
ds_read_b64_tr_b16 v[192:193], v241 offset:0
ds_read_b64_tr_b16 v[194:195], v241 offset:512
v_mfma_f32_32x32x16_bf16 v[16:31], v[148:151], v[204:207], v[16:31]
ds_read_b64_tr_b16 v[196:197], v241 offset:2048
ds_read_b64_tr_b16 v[198:199], v241 offset:2560
s_waitcnt lgkmcnt(4)
v_mfma_f32_32x32x16_bf16 v[16:31], v[152:155], v[208:211], v[16:31]
ds_read_b64_tr_b16 v[200:201], v241 offset:4096
ds_read_b64_tr_b16 v[202:203], v241 offset:4608
v_mfma_f32_32x32x16_bf16 v[16:31], v[156:159], v[212:215], v[16:31]
ds_read_b64_tr_b16 v[204:205], v241 offset:6144
ds_read_b64_tr_b16 v[206:207], v241 offset:6656
s_waitcnt lgkmcnt(4)
v_mfma_f32_32x32x16_bf16 v[32:47], v[96:99], v[192:195], v[32:47]
ds_read_b64_tr_b16 v[208:209], v241 offset:8192
ds_read_b64_tr_b16 v[210:211], v241 offset:8704
v_mfma_f32_32x32x16_bf16 v[32:47], v[100:103], v[196:199], v[32:47]
ds_read_b64_tr_b16 v[212:213], v241 offset:10240
ds_read_b64_tr_b16 v[214:215], v241 offset:10752
s_nop 2
v_cvt_pk_bf16_f32 v168, v16, v17
v_pk_add_u16 v168, s56, v168
s_waitcnt lgkmcnt(4)
v_mfma_f32_32x32x16_bf16 v[32:47], v[104:107], v[200:203], v[32:47]
ds_read_b64_tr_b16 v[192:193], v241 offset:12288
ds_read_b64_tr_b16 v[194:195], v241 offset:12800
s_xor_b32 s46, s5, 2
s_lshl_b32 s46, s46, 17
s_add_u32 s46, s46, s50
v_mfma_f32_32x32x16_bf16 v[32:47], v[108:111], v[204:207], v[32:47]
ds_read_b64_tr_b16 v[196:197], v241 offset:14336
ds_read_b64_tr_b16 v[198:199], v241 offset:14848
v_cvt_pk_bf16_f32 v169, v18, v19
v_pk_add_u16 v169, s56, v169
s_waitcnt lgkmcnt(4)
v_mfma_f32_32x32x16_bf16 v[32:47], v[112:115], v[208:211], v[32:47]
v_add_u32 v242, 69632, v229
ds_read_b64_tr_b16 v[200:201], v242 offset:0
ds_read_b64_tr_b16 v[202:203], v242 offset:512
v_cvt_pk_bf16_f32 v170, v20, v21
v_mfma_f32_32x32x16_bf16 v[32:47], v[116:119], v[212:215], v[32:47]
ds_read_b64_tr_b16 v[204:205], v242 offset:2048
ds_read_b64_tr_b16 v[206:207], v242 offset:2560
v_pk_add_u16 v170, s56, v170
v_cvt_pk_bf16_f32 v171, v22, v23
s_waitcnt lgkmcnt(4)
v_mfma_f32_32x32x16_bf16 v[32:47], v[120:123], v[192:195], v[32:47]
ds_read_b64_tr_b16 v[208:209], v242 offset:4096
ds_read_b64_tr_b16 v[210:211], v242 offset:4608
v_pk_add_u16 v171, s56, v171
s_add_u32 s44, s46, 8192
buffer_store_dwordx4 v[168:171], v234, s[32:35], s44 offen sc1
v_mfma_f32_32x32x16_bf16 v[32:47], v[124:127], v[196:199], v[32:47]
ds_read_b64_tr_b16 v[212:213], v242 offset:6144
ds_read_b64_tr_b16 v[214:215], v242 offset:6656
v_cvt_pk_bf16_f32 v172, v24, v25
v_pk_add_u16 v172, s56, v172
s_waitcnt lgkmcnt(4)
v_mfma_f32_32x32x16_bf16 v[32:47], v[128:131], v[200:203], v[32:47]
ds_read_b64_tr_b16 v[192:193], v242 offset:8192
ds_read_b64_tr_b16 v[194:195], v242 offset:8704
v_cvt_pk_bf16_f32 v173, v26, v27
v_pk_add_u16 v173, s56, v173
v_mfma_f32_32x32x16_bf16 v[32:47], v[132:135], v[204:207], v[32:47]
ds_read_b64_tr_b16 v[196:197], v242 offset:10240
ds_read_b64_tr_b16 v[198:199], v242 offset:10752
v_cvt_pk_bf16_f32 v174, v28, v29
v_pk_add_u16 v174, s56, v174
s_waitcnt lgkmcnt(4)
v_mfma_f32_32x32x16_bf16 v[32:47], v[136:139], v[208:211], v[32:47]
ds_read_b64_tr_b16 v[200:201], v242 offset:12288
ds_read_b64_tr_b16 v[202:203], v242 offset:12800
v_cvt_pk_bf16_f32 v175, v30, v31
v_pk_add_u16 v175, s56, v175
v_mfma_f32_32x32x16_bf16 v[32:47], v[140:143], v[212:215], v[32:47]
ds_read_b64_tr_b16 v[204:205], v242 offset:14336
ds_read_b64_tr_b16 v[206:207], v242 offset:14848
s_add_u32 s44, s46, 12288
buffer_store_dwordx4 v[172:175], v234, s[32:35], s44 offen sc1
s_waitcnt lgkmcnt(4)
v_mfma_f32_32x32x16_bf16 v[32:47], v[144:147], v[192:195], v[32:47]
ds_read_b64_tr_b16 v[208:209], v241 offset:256
ds_read_b64_tr_b16 v[210:211], v241 offset:768
v_mfma_f32_32x32x16_bf16 v[32:47], v[148:151], v[196:199], v[32:47]
ds_read_b64_tr_b16 v[212:213], v241 offset:2304
ds_read_b64_tr_b16 v[214:215], v241 offset:2816
s_waitcnt lgkmcnt(4)
v_mfma_f32_32x32x16_bf16 v[32:47], v[152:155], v[200:203], v[32:47]
ds_read_b64_tr_b16 v[192:193], v241 offset:4352
ds_read_b64_tr_b16 v[194:195], v241 offset:4864
v_mfma_f32_32x32x16_bf16 v[32:47], v[156:159], v[204:207], v[32:47]
ds_read_b64_tr_b16 v[196:197], v241 offset:6400
ds_read_b64_tr_b16 v[198:199], v241 offset:6912
s_waitcnt lgkmcnt(4)
v_mfma_f32_32x32x16_bf16 v[48:63], v[96:99], v[208:211], v[48:63]
ds_read_b64_tr_b16 v[200:201], v241 offset:8448
ds_read_b64_tr_b16 v[202:203], v241 offset:8960
v_mfma_f32_32x32x16_bf16 v[48:63], v[100:103], v[212:215], v[48:63]
ds_read_b64_tr_b16 v[204:205], v241 offset:10496
ds_read_b64_tr_b16 v[206:207], v241 offset:11008
s_nop 2
v_cvt_pk_bf16_f32 v176, v32, v33
v_pk_add_u16 v176, s56, v176
s_waitcnt lgkmcnt(4)
v_mfma_f32_32x32x16_bf16 v[48:63], v[104:107], v[192:195], v[48:63]
ds_read_b64_tr_b16 v[208:209], v241 offset:12544
ds_read_b64_tr_b16 v[210:211], v241 offset:13056
s_xor_b32 s46, s5, 1
s_lshl_b32 s46, s46, 17
s_add_u32 s46, s46, s50
v_mfma_f32_32x32x16_bf16 v[48:63], v[108:111], v[196:199], v[48:63]
ds_read_b64_tr_b16 v[212:213], v241 offset:14592
ds_read_b64_tr_b16 v[214:215], v241 offset:15104
v_cvt_pk_bf16_f32 v177, v34, v35
v_pk_add_u16 v177, s56, v177
s_waitcnt lgkmcnt(4)
v_mfma_f32_32x32x16_bf16 v[48:63], v[112:115], v[200:203], v[48:63]
ds_read_b64_tr_b16 v[192:193], v242 offset:256
ds_read_b64_tr_b16 v[194:195], v242 offset:768
v_cvt_pk_bf16_f32 v178, v36, v37
v_pk_add_u16 v178, s56, v178
v_mfma_f32_32x32x16_bf16 v[48:63], v[116:119], v[204:207], v[48:63]
ds_read_b64_tr_b16 v[196:197], v242 offset:2304
ds_read_b64_tr_b16 v[198:199], v242 offset:2816
v_cvt_pk_bf16_f32 v179, v38, v39
v_pk_add_u16 v179, s56, v179
s_waitcnt lgkmcnt(4)
v_mfma_f32_32x32x16_bf16 v[48:63], v[120:123], v[208:211], v[48:63]
ds_read_b64_tr_b16 v[200:201], v242 offset:4352
ds_read_b64_tr_b16 v[202:203], v242 offset:4864
s_add_u32 s44, s46, 16384
buffer_store_dwordx4 v[176:179], v234, s[32:35], s44 offen sc1
v_mfma_f32_32x32x16_bf16 v[48:63], v[124:127], v[212:215], v[48:63]
ds_read_b64_tr_b16 v[204:205], v242 offset:6400
ds_read_b64_tr_b16 v[206:207], v242 offset:6912
v_cvt_pk_bf16_f32 v180, v40, v41
v_pk_add_u16 v180, s56, v180
s_waitcnt lgkmcnt(4)
v_mfma_f32_32x32x16_bf16 v[48:63], v[128:131], v[192:195], v[48:63]
ds_read_b64_tr_b16 v[208:209], v242 offset:8448
ds_read_b64_tr_b16 v[210:211], v242 offset:8960
v_cvt_pk_bf16_f32 v181, v42, v43
v_pk_add_u16 v181, s56, v181
v_mfma_f32_32x32x16_bf16 v[48:63], v[132:135], v[196:199], v[48:63]
ds_read_b64_tr_b16 v[212:213], v242 offset:10496
ds_read_b64_tr_b16 v[214:215], v242 offset:11008
v_cvt_pk_bf16_f32 v182, v44, v45
v_pk_add_u16 v182, s56, v182
s_waitcnt lgkmcnt(4)
v_mfma_f32_32x32x16_bf16 v[48:63], v[136:139], v[200:203], v[48:63]
ds_read_b64_tr_b16 v[192:193], v242 offset:12544
ds_read_b64_tr_b16 v[194:195], v242 offset:13056
v_cvt_pk_bf16_f32 v183, v46, v47
v_pk_add_u16 v183, s56, v183
v_mfma_f32_32x32x16_bf16 v[48:63], v[140:143], v[204:207], v[48:63]
ds_read_b64_tr_b16 v[196:197], v242 offset:14592
ds_read_b64_tr_b16 v[198:199], v242 offset:15104
s_add_u32 s44, s46, 20480
buffer_store_dwordx4 v[180:183], v234, s[32:35], s44 offen sc1
s_waitcnt lgkmcnt(4)
v_mfma_f32_32x32x16_bf16 v[48:63], v[144:147], v[208:211], v[48:63]
v_mfma_f32_32x32x16_bf16 v[48:63], v[148:151], v[212:215], v[48:63]
s_waitcnt lgkmcnt(0)
v_mfma_f32_32x32x16_bf16 v[48:63], v[152:155], v[192:195], v[48:63]
v_mfma_f32_32x32x16_bf16 v[48:63], v[156:159], v[196:199], v[48:63]
s_nop 7
s_add_u32 s45, s53, 0
buffer_load_dwordx4 v[0:3], v234, s[32:35], s45 offen sc1
s_add_u32 s45, s53, 4096
buffer_load_dwordx4 v[4:7], v234, s[32:35], s45 offen sc1
s_add_u32 s45, s53, 8192
buffer_load_dwordx4 v[8:11], v234, s[32:35], s45 offen sc1
s_add_u32 s45, s53, 12288
buffer_load_dwordx4 v[12:15], v234, s[32:35], s45 offen sc1
s_add_u32 s45, s53, 16384
buffer_load_dwordx4 v[16:19], v234, s[32:35], s45 offen sc1
s_add_u32 s45, s53, 20480
buffer_load_dwordx4 v[20:23], v234, s[32:35], s45 offen sc1
s_mov_b32 s55, 0
L_zspin:
ds_read_b32 v238, v236 offset:1760
v_add_u32 v239, 86016, v234
v_add_u32 v240, 36864, v234
s_waitcnt lgkmcnt(0)
v_cmp_ne_u32 vcc, 1, v238
s_nop 1
s_cbranch_vccz L_zok
s_add_u32 s57, s57, 1
s_cmp_gt_u32 s57, 4194304
s_cbranch_scc1 L_zok
s_branch L_zspin
L_zok:
ds_read_b128 v[64:67], v239 offset:0
ds_read_b128 v[68:71], v239 offset:4096
ds_read_b128 v[72:75], v239 offset:8192
ds_read_b128 v[76:79], v239 offset:12288
ds_read_b128 v[80:83], v240 offset:0
ds_read_b128 v[84:87], v240 offset:4096
s_waitcnt vmcnt(5) lgkmcnt(0)
v_xor_b32 v192, v0, v64
v_xor_b32 v193, v1, v65
v_xor_b32 v194, v2, v66
v_xor_b32 v195, v3, v67
v_min_u32 v196, v192, v193
v_min3_u32 v196, v196, v194, v195
s_waitcnt vmcnt(4) lgkmcnt(0)
v_xor_b32 v192, v4, v68
v_xor_b32 v193, v5, v69
v_xor_b32 v194, v6, v70
v_xor_b32 v195, v7, v71
v_min3_u32 v196, v196, v192, v193
v_min3_u32 v196, v196, v194, v195
s_waitcnt vmcnt(3) lgkmcnt(0)
v_xor_b32 v192, v8, v72
v_xor_b32 v193, v9, v73
v_xor_b32 v194, v10, v74
v_xor_b32 v195, v11, v75
v_min3_u32 v196, v196, v192, v193
v_min3_u32 v196, v196, v194, v195
s_waitcnt vmcnt(2) lgkmcnt(0)
v_xor_b32 v192, v12, v76
v_xor_b32 v193, v13, v77
v_xor_b32 v194, v14, v78
v_xor_b32 v195, v15, v79
v_min3_u32 v196, v196, v192, v193
v_min3_u32 v196, v196, v194, v195
v_cmp_eq_u32 vcc, 0, v196
s_add_u32 s45, s56, 4
v_mov_b32 v254, s45
s_mov_b64 exec, 1
buffer_store_dword v254, v235, s[32:35], s49 offen sc1
s_mov_b64 exec, -1
s_cbranch_vccz L_fa_ok
L_fa:
s_add_u32 s45, s53, 0
buffer_load_dwordx4 v[0:3], v234, s[32:35], s45 offen sc1
s_add_u32 s45, s53, 4096
buffer_load_dwordx4 v[4:7], v234, s[32:35], s45 offen sc1
s_add_u32 s45, s53, 8192
buffer_load_dwordx4 v[8:11], v234, s[32:35], s45 offen sc1
s_add_u32 s45, s53, 12288
buffer_load_dwordx4 v[12:15], v234, s[32:35], s45 offen sc1
s_waitcnt vmcnt(3) lgkmcnt(0)
v_xor_b32 v192, v0, v64
v_xor_b32 v193, v1, v65
v_xor_b32 v194, v2, v66
v_xor_b32 v195, v3, v67
v_min_u32 v196, v192, v193
v_min3_u32 v196, v196, v194, v195
s_waitcnt vmcnt(2) lgkmcnt(0)
v_xor_b32 v192, v4, v68
v_xor_b32 v193, v5, v69
v_xor_b32 v194, v6, v70
v_xor_b32 v195, v7, v71
v_min3_u32 v196, v196, v192, v193
v_min3_u32 v196, v196, v194, v195
s_waitcnt vmcnt(1) lgkmcnt(0)
v_xor_b32 v192, v8, v72
v_xor_b32 v193, v9, v73
v_xor_b32 v194, v10, v74
v_xor_b32 v195, v11, v75
v_min3_u32 v196, v196, v192, v193
v_min3_u32 v196, v196, v194, v195
s_waitcnt vmcnt(0) lgkmcnt(0)
v_xor_b32 v192, v12, v76
v_xor_b32 v193, v13, v77
v_xor_b32 v194, v14, v78
v_xor_b32 v195, v15, v79
v_min3_u32 v196, v196, v192, v193
v_min3_u32 v196, v196, v194, v195
v_cmp_eq_u32 vcc, 0, v196
s_nop 1
s_cbranch_vccz L_fa_ok
s_bitcmp1_b32 s55, 31
s_cbranch_scc1 L_fa_ok
s_add_u32 s55, s55, 1
s_cmp_lt_u32 s55, 48
s_cbranch_scc1 L_fa
s_call_b64 s[92:93], L_fslow
s_branch L_fa
L_fa_ok:
v_lshl_add_u32 v198, v0, 16, s11
v_and_b32 v199, 0xffff0000, v0
v_pk_add_f32 v[48:49], v[48:49], v[198:199]
v_lshl_add_u32 v200, v1, 16, s11
v_and_b32 v201, 0xffff0000, v1
v_pk_add_f32 v[50:51], v[50:51], v[200:201]
v_lshl_add_u32 v198, v2, 16, s11
v_and_b32 v199, 0xffff0000, v2
v_pk_add_f32 v[52:53], v[52:53], v[198:199]
v_lshl_add_u32 v200, v3, 16, s11
v_and_b32 v201, 0xffff0000, v3
v_pk_add_f32 v[54:55], v[54:55], v[200:201]
v_lshl_add_u32 v198, v4, 16, s11
v_and_b32 v199, 0xffff0000, v4
v_pk_add_f32 v[56:57], v[56:57], v[198:199]
v_lshl_add_u32 v200, v5, 16, s11
v_and_b32 v201, 0xffff0000, v5
v_pk_add_f32 v[58:59], v[58:59], v[200:201]
v_lshl_add_u32 v198, v6, 16, s11
v_and_b32 v199, 0xffff0000, v6
v_pk_add_f32 v[60:61], v[60:61], v[198:199]
v_lshl_add_u32 v200, v7, 16, s11
v_and_b32 v201, 0xffff0000, v7
v_pk_add_f32 v[62:63], v[62:63], v[200:201]
v_lshl_add_u32 v198, v8, 16, s11
v_and_b32 v199, 0xffff0000, v8
v_pk_add_f32 v[48:49], v[48:49], v[198:199]
v_lshl_add_u32 v200, v9, 16, s11
v_and_b32 v201, 0xffff0000, v9
v_pk_add_f32 v[50:51], v[50:51], v[200:201]
v_lshl_add_u32 v198, v10, 16, s11
v_and_b32 v199, 0xffff0000, v10
v_pk_add_f32 v[52:53], v[52:53], v[198:199]
v_lshl_add_u32 v200, v11, 16, s11
v_and_b32 v201, 0xffff0000, v11
v_pk_add_f32 v[54:55], v[54:55], v[200:201]
v_lshl_add_u32 v198, v12, 16, s11
v_and_b32 v199, 0xffff0000, v12
v_pk_add_f32 v[56:57], v[56:57], v[198:199]
v_lshl_add_u32 v200, v13, 16, s11
v_and_b32 v201, 0xffff0000, v13
v_pk_add_f32 v[58:59], v[58:59], v[200:201]
v_lshl_add_u32 v198, v14, 16, s11
v_and_b32 v199, 0xffff0000, v14
v_pk_add_f32 v[60:61], v[60:61], v[198:199]
v_lshl_add_u32 v200, v15, 16, s11
v_and_b32 v201, 0xffff0000, v15
v_pk_add_f32 v[62:63], v[62:63], v[200:201]
s_waitcnt vmcnt(2) lgkmcnt(0)
v_xor_b32 v192, v16, v80
v_xor_b32 v193, v17, v81
v_xor_b32 v194, v18, v82
v_xor_b32 v195, v19, v83
v_min_u32 v196, v192, v193
v_min3_u32 v196, v196, v194, v195
s_waitcnt vmcnt(1) lgkmcnt(0)
v_xor_b32 v192, v20, v84
v_xor_b32 v193, v21, v85
v_xor_b32 v194, v22, v86
v_xor_b32 v195, v23, v87
v_min3_u32 v196, v196, v192, v193
v_min3_u32 v196, v196, v194, v195
v_cmp_eq_u32 vcc, 0, v196
s_nop 0
s_cbranch_vccz L_fb_ok
L_fb:
s_add_u32 s45, s53, 16384
buffer_load_dwordx4 v[16:19], v234, s[32:35], s45 offen sc1
s_add_u32 s45, s53, 20480
buffer_load_dwordx4 v[20:23], v234, s[32:35], s45 offen sc1
s_waitcnt vmcnt(1) lgkmcnt(0)
v_xor_b32 v192, v16, v80
v_xor_b32 v193, v17, v81
v_xor_b32 v194, v18, v82
v_xor_b32 v195, v19, v83
v_min_u32 v196, v192, v193
v_min3_u32 v196, v196, v194, v195
s_waitcnt vmcnt(0) lgkmcnt(0)
v_xor_b32 v192, v20, v84
v_xor_b32 v193, v21, v85
v_xor_b32 v194, v22, v86
v_xor_b32 v195, v23, v87
v_min3_u32 v196, v196, v192, v193
v_min3_u32 v196, v196, v194, v195
v_cmp_eq_u32 vcc, 0, v196
s_nop 1
s_cbranch_vccz L_fb_ok
s_bitcmp1_b32 s55, 31
s_cbranch_scc1 L_fb_ok
s_add_u32 s55, s55, 1
s_cmp_lt_u32 s55, 48
s_cbranch_scc1 L_fb
s_call_b64 s[92:93], L_fslow
s_branch L_fb
L_fb_ok:
v_lshl_add_u32 v198, v16, 16, s11
v_and_b32 v199, 0xffff0000, v16
v_pk_add_f32 v[48:49], v[48:49], v[198:199]
v_lshl_add_u32 v200, v17, 16, s11
v_and_b32 v201, 0xffff0000, v17
v_pk_add_f32 v[50:51], v[50:51], v[200:201]
v_lshl_add_u32 v198, v18, 16, s11
v_and_b32 v199, 0xffff0000, v18
v_pk_add_f32 v[52:53], v[52:53], v[198:199]
v_lshl_add_u32 v200, v19, 16, s11
v_and_b32 v201, 0xffff0000, v19
v_pk_add_f32 v[54:55], v[54:55], v[200:201]
v_lshl_add_u32 v198, v20, 16, s11
v_and_b32 v199, 0xffff0000, v20
v_pk_add_f32 v[56:57], v[56:57], v[198:199]
v_lshl_add_u32 v200, v21, 16, s11
v_and_b32 v201, 0xffff0000, v21
v_pk_add_f32 v[58:59], v[58:59], v[200:201]
v_lshl_add_u32 v198, v22, 16, s11
v_and_b32 v199, 0xffff0000, v22
v_pk_add_f32 v[60:61], v[60:61], v[198:199]
v_lshl_add_u32 v200, v23, 16, s11
v_and_b32 v201, 0xffff0000, v23
v_pk_add_f32 v[62:63], v[62:63], v[200:201]
s_add_u32 s44, s52, 0
v_cvt_pk_bf16_f32 v96, v48, v49
buffer_store_short v96, v255, s[36:39], s44 offen
buffer_store_short_d16_hi v96, v255, s[36:39], s44 offen offset:2304
s_add_u32 s44, s52, 4608
v_cvt_pk_bf16_f32 v97, v50, v51
buffer_store_short v97, v255, s[36:39], s44 offen
buffer_store_short_d16_hi v97, v255, s[36:39], s44 offen offset:2304
s_add_u32 s44, s52, 18432
v_cvt_pk_bf16_f32 v98, v52, v53
buffer_store_short v98, v255, s[36:39], s44 offen
buffer_store_short_d16_hi v98, v255, s[36:39], s44 offen offset:2304
s_add_u32 s44, s52, 23040
v_cvt_pk_bf16_f32 v99, v54, v55
buffer_store_short v99, v255, s[36:39], s44 offen
buffer_store_short_d16_hi v99, v255, s[36:39], s44 offen offset:2304
s_add_u32 s44, s52, 36864
v_cvt_pk_bf16_f32 v100, v56, v57
buffer_store_short v100, v255, s[36:39], s44 offen
buffer_store_short_d16_hi v100, v255, s[36:39], s44 offen offset:2304
s_add_u32 s44, s52, 41472
v_cvt_pk_bf16_f32 v101, v58, v59
buffer_store_short v101, v255, s[36:39], s44 offen
buffer_store_short_d16_hi v101, v255, s[36:39], s44 offen offset:2304
s_add_u32 s44, s52, 55296
v_cvt_pk_bf16_f32 v102, v60, v61
buffer_store_short v102, v255, s[36:39], s44 offen
buffer_store_short_d16_hi v102, v255, s[36:39], s44 offen offset:2304
s_add_u32 s44, s52, 59904
v_cvt_pk_bf16_f32 v103, v62, v63
buffer_store_short v103, v255, s[36:39], s44 offen
buffer_store_short_d16_hi v103, v255, s[36:39], s44 offen offset:2304
L_end:
s_endpgm
L_spin0:
ds_read_b32 v238, v236 offset:0
s_waitcnt lgkmcnt(0)
v_cmp_ne_u32 vcc, 1, v238
s_nop 1
s_cbranch_vccz L_back0

s_add_u32 s57, s57, 1
s_cmp_gt_u32 s57, 4194304
s_cbranch_scc1 L_back0
s_branch L_spin0
L_spin1:
ds_read_b32 v238, v236 offset:32
s_waitcnt lgkmcnt(0)
v_cmp_ne_u32 vcc, 1, v238
s_nop 1
s_cbranch_vccz L_back1

s_add_u32 s57, s57, 1
s_cmp_gt_u32 s57, 4194304
s_cbranch_scc1 L_back1
s_branch L_spin1
L_spin2:
ds_read_b32 v238, v236 offset:64
s_waitcnt lgkmcnt(0)
v_cmp_ne_u32 vcc, 1, v238
s_nop 1
s_cbranch_vccz L_back2

s_add_u32 s57, s57, 1
s_cmp_gt_u32 s57, 4194304
s_cbranch_scc1 L_back2
s_branch L_spin2
L_spin3:
ds_read_b32 v238, v236 offset:96
s_waitcnt lgkmcnt(0)
v_cmp_ne_u32 vcc, 1, v238
s_nop 1
s_cbranch_vccz L_back3

s_add_u32 s57, s57, 1
s_cmp_gt_u32 s57, 4194304
s_cbranch_scc1 L_back3
s_branch L_spin3
L_spin4:
ds_read_b32 v238, v236 offset:128
s_waitcnt lgkmcnt(0)
v_cmp_ne_u32 vcc, 1, v238
s_nop 1
s_cbranch_vccz L_back4

s_add_u32 s57, s57, 1
s_cmp_gt_u32 s57, 4194304
s_cbranch_scc1 L_back4
s_branch L_spin4
L_spin5:
ds_read_b32 v238, v236 offset:160
s_waitcnt lgkmcnt(0)
v_cmp_ne_u32 vcc, 1, v238
s_nop 1
s_cbranch_vccz L_back5

s_add_u32 s57, s57, 1
s_cmp_gt_u32 s57, 4194304
s_cbranch_scc1 L_back5
s_branch L_spin5
L_spin6:
ds_read_b32 v238, v236 offset:192
s_waitcnt lgkmcnt(0)
v_cmp_ne_u32 vcc, 1, v238
s_nop 1
s_cbranch_vccz L_back6

s_add_u32 s57, s57, 1
s_cmp_gt_u32 s57, 4194304
s_cbranch_scc1 L_back6
s_branch L_spin6
L_spin7:
ds_read_b32 v238, v236 offset:224
s_waitcnt lgkmcnt(0)
v_cmp_ne_u32 vcc, 1, v238
s_nop 1
s_cbranch_vccz L_back7

s_add_u32 s57, s57, 1
s_cmp_gt_u32 s57, 4194304
s_cbranch_scc1 L_back7
s_branch L_spin7
L_spin8:
ds_read_b32 v238, v236 offset:256
s_waitcnt lgkmcnt(0)
v_cmp_ne_u32 vcc, 1, v238
s_nop 1
s_cbranch_vccz L_back8

s_add_u32 s57, s57, 1
s_cmp_gt_u32 s57, 4194304
s_cbranch_scc1 L_back8
s_branch L_spin8
L_spin9:
ds_read_b32 v238, v236 offset:288
s_waitcnt lgkmcnt(0)
v_cmp_ne_u32 vcc, 1, v238
s_nop 1
s_cbranch_vccz L_back9

s_add_u32 s57, s57, 1
s_cmp_gt_u32 s57, 4194304
s_cbranch_scc1 L_back9
s_branch L_spin9
L_spin10:
ds_read_b32 v238, v236 offset:320
s_waitcnt lgkmcnt(0)
v_cmp_ne_u32 vcc, 1, v238
s_nop 1
s_cbranch_vccz L_back10

s_add_u32 s57, s57, 1
s_cmp_gt_u32 s57, 4194304
s_cbranch_scc1 L_back10
s_branch L_spin10
L_spin11:
ds_read_b32 v238, v236 offset:352
s_waitcnt lgkmcnt(0)
v_cmp_ne_u32 vcc, 1, v238
s_nop 1
s_cbranch_vccz L_back11

s_add_u32 s57, s57, 1
s_cmp_gt_u32 s57, 4194304
s_cbranch_scc1 L_back11
s_branch L_spin11
L_spin12:
ds_read_b32 v238, v236 offset:384
s_waitcnt lgkmcnt(0)
v_cmp_ne_u32 vcc, 1, v238
s_nop 1
s_cbranch_vccz L_back12

s_add_u32 s57, s57, 1
s_cmp_gt_u32 s57, 4194304
s_cbranch_scc1 L_back12
s_branch L_spin12
L_spin13:
ds_read_b32 v238, v236 offset:416
s_waitcnt lgkmcnt(0)
v_cmp_ne_u32 vcc, 1, v238
s_nop 1
s_cbranch_vccz L_back13

s_add_u32 s57, s57, 1
s_cmp_gt_u32 s57, 4194304
s_cbranch_scc1 L_back13
s_branch L_spin13
L_spin14:
ds_read_b32 v238, v236 offset:448
s_waitcnt lgkmcnt(0)
v_cmp_ne_u32 vcc, 1, v238
s_nop 1
s_cbranch_vccz L_back14

s_add_u32 s57, s57, 1
s_cmp_gt_u32 s57, 4194304
s_cbranch_scc1 L_back14
s_branch L_spin14
L_spin15:
ds_read_b32 v238, v236 offset:480
s_waitcnt lgkmcnt(0)
v_cmp_ne_u32 vcc, 1, v238
s_nop 1
s_cbranch_vccz L_back15

s_add_u32 s57, s57, 1
s_cmp_gt_u32 s57, 4194304
s_cbranch_scc1 L_back15
s_branch L_spin15
L_spin16:
ds_read_b32 v238, v236 offset:512
s_waitcnt lgkmcnt(0)
v_cmp_ne_u32 vcc, 1, v238
s_nop 1
s_cbranch_vccz L_back16

s_add_u32 s57, s57, 1
s_cmp_gt_u32 s57, 4194304
s_cbranch_scc1 L_back16
s_branch L_spin16
L_spin17:
ds_read_b32 v238, v236 offset:544
s_waitcnt lgkmcnt(0)
v_cmp_ne_u32 vcc, 1, v238
s_nop 1
s_cbranch_vccz L_back17

s_add_u32 s57, s57, 1
s_cmp_gt_u32 s57, 4194304
s_cbranch_scc1 L_back17
s_branch L_spin17
L_spin18:
ds_read_b32 v238, v236 offset:576
s_waitcnt lgkmcnt(0)
v_cmp_ne_u32 vcc, 1, v238
s_nop 1
s_cbranch_vccz L_back18

s_add_u32 s57, s57, 1
s_cmp_gt_u32 s57, 4194304
s_cbranch_scc1 L_back18
s_branch L_spin18
L_spin19:
ds_read_b32 v238, v236 offset:608
s_waitcnt lgkmcnt(0)
v_cmp_ne_u32 vcc, 1, v238
s_nop 1
s_cbranch_vccz L_back19

s_add_u32 s57, s57, 1
s_cmp_gt_u32 s57, 4194304
s_cbranch_scc1 L_back19
s_branch L_spin19
L_spin20:
ds_read_b32 v238, v236 offset:640
s_waitcnt lgkmcnt(0)
v_cmp_ne_u32 vcc, 1, v238
s_nop 1
s_cbranch_vccz L_back20

s_add_u32 s57, s57, 1
s_cmp_gt_u32 s57, 4194304
s_cbranch_scc1 L_back20
s_branch L_spin20
L_spin21:
ds_read_b32 v238, v236 offset:672
s_waitcnt lgkmcnt(0)
v_cmp_ne_u32 vcc, 1, v238
s_nop 1
s_cbranch_vccz L_back21

s_add_u32 s57, s57, 1
s_cmp_gt_u32 s57, 4194304
s_cbranch_scc1 L_back21
s_branch L_spin21
L_spin22:
ds_read_b32 v238, v236 offset:704
s_waitcnt lgkmcnt(0)
v_cmp_ne_u32 vcc, 1, v238
s_nop 1
s_cbranch_vccz L_back22

s_add_u32 s57, s57, 1
s_cmp_gt_u32 s57, 4194304
s_cbranch_scc1 L_back22
s_branch L_spin22
L_spin23:
ds_read_b32 v238, v236 offset:736
s_waitcnt lgkmcnt(0)
v_cmp_ne_u32 vcc, 1, v238
s_nop 1
s_cbranch_vccz L_back23

s_add_u32 s57, s57, 1
s_cmp_gt_u32 s57, 4194304
s_cbranch_scc1 L_back23
s_branch L_spin23
L_spin24:
ds_read_b32 v238, v236 offset:768
s_waitcnt lgkmcnt(0)
v_cmp_ne_u32 vcc, 1, v238
s_nop 1
s_cbranch_vccz L_back24

s_add_u32 s57, s57, 1
s_cmp_gt_u32 s57, 4194304
s_cbranch_scc1 L_back24
s_branch L_spin24
L_spin25:
ds_read_b32 v238, v236 offset:800
s_waitcnt lgkmcnt(0)
v_cmp_ne_u32 vcc, 1, v238
s_nop 1
s_cbranch_vccz L_back25

s_add_u32 s57, s57, 1
s_cmp_gt_u32 s57, 4194304
s_cbranch_scc1 L_back25
s_branch L_spin25
L_spin26:
ds_read_b32 v238, v236 offset:832
s_waitcnt lgkmcnt(0)
v_cmp_ne_u32 vcc, 1, v238
s_nop 1
s_cbranch_vccz L_back26

s_add_u32 s57, s57, 1
s_cmp_gt_u32 s57, 4194304
s_cbranch_scc1 L_back26
s_branch L_spin26
L_spin27:
ds_read_b32 v238, v236 offset:864
s_waitcnt lgkmcnt(0)
v_cmp_ne_u32 vcc, 1, v238
s_nop 1
s_cbranch_vccz L_back27

s_add_u32 s57, s57, 1
s_cmp_gt_u32 s57, 4194304
s_cbranch_scc1 L_back27
s_branch L_spin27
L_spin28:
ds_read_b32 v238, v236 offset:896
s_waitcnt lgkmcnt(0)
v_cmp_ne_u32 vcc, 1, v238
s_nop 1
s_cbranch_vccz L_back28

s_add_u32 s57, s57, 1
s_cmp_gt_u32 s57, 4194304
s_cbranch_scc1 L_back28
s_branch L_spin28
L_spin29:
ds_read_b32 v238, v236 offset:928
s_waitcnt lgkmcnt(0)
v_cmp_ne_u32 vcc, 1, v238
s_nop 1
s_cbranch_vccz L_back29

s_add_u32 s57, s57, 1
s_cmp_gt_u32 s57, 4194304
s_cbranch_scc1 L_back29
s_branch L_spin29
L_spin30:
ds_read_b32 v238, v236 offset:960
s_waitcnt lgkmcnt(0)
v_cmp_ne_u32 vcc, 1, v238
s_nop 1
s_cbranch_vccz L_back30

s_add_u32 s57, s57, 1
s_cmp_gt_u32 s57, 4194304
s_cbranch_scc1 L_back30
s_branch L_spin30
L_spin31:
ds_read_b32 v238, v236 offset:992
s_waitcnt lgkmcnt(0)
v_cmp_ne_u32 vcc, 1, v238
s_nop 1
s_cbranch_vccz L_back31

s_add_u32 s57, s57, 1
s_cmp_gt_u32 s57, 4194304
s_cbranch_scc1 L_back31
s_branch L_spin31
L_spin32:
ds_read_b32 v238, v236 offset:1024
s_waitcnt lgkmcnt(0)
v_cmp_ne_u32 vcc, 1, v238
s_nop 1
s_cbranch_vccz L_back32

s_add_u32 s57, s57, 1
s_cmp_gt_u32 s57, 4194304
s_cbranch_scc1 L_back32
s_branch L_spin32
L_spin34:
ds_read_b32 v238, v236 offset:1088
s_waitcnt lgkmcnt(0)
v_cmp_ne_u32 vcc, 1, v238
s_nop 1
s_cbranch_vccz L_back34

s_add_u32 s57, s57, 1
s_cmp_gt_u32 s57, 4194304
s_cbranch_scc1 L_back34
s_branch L_spin34
L_spin36:
ds_read_b32 v238, v236 offset:1152
s_waitcnt lgkmcnt(0)
v_cmp_ne_u32 vcc, 1, v238
s_nop 1
s_cbranch_vccz L_back36

s_add_u32 s57, s57, 1
s_cmp_gt_u32 s57, 4194304
s_cbranch_scc1 L_back36
s_branch L_spin36
L_spin38:
ds_read_b32 v238, v236 offset:1216
s_waitcnt lgkmcnt(0)
v_cmp_ne_u32 vcc, 1, v238
s_nop 1
s_cbranch_vccz L_back38

s_add_u32 s57, s57, 1
s_cmp_gt_u32 s57, 4194304
s_cbranch_scc1 L_back38
s_branch L_spin38
L_spin40:
ds_read_b32 v238, v236 offset:1280
s_waitcnt lgkmcnt(0)
v_cmp_ne_u32 vcc, 1, v238
s_nop 1
s_cbranch_vccz L_back40

s_add_u32 s57, s57, 1
s_cmp_gt_u32 s57, 4194304
s_cbranch_scc1 L_back40
s_branch L_spin40
L_spin42:
ds_read_b32 v238, v236 offset:1344
s_waitcnt lgkmcnt(0)
v_cmp_ne_u32 vcc, 1, v238
s_nop 1
s_cbranch_vccz L_back42

s_add_u32 s57, s57, 1
s_cmp_gt_u32 s57, 4194304
s_cbranch_scc1 L_back42
s_branch L_spin42
L_spin44:
ds_read_b32 v238, v236 offset:1408
s_waitcnt lgkmcnt(0)
v_cmp_ne_u32 vcc, 1, v238
s_nop 1
s_cbranch_vccz L_back44

s_add_u32 s57, s57, 1
s_cmp_gt_u32 s57, 4194304
s_cbranch_scc1 L_back44
s_branch L_spin44
L_spin46:
ds_read_b32 v238, v236 offset:1472
s_waitcnt lgkmcnt(0)
v_cmp_ne_u32 vcc, 1, v238
s_nop 1
s_cbranch_vccz L_back46

s_add_u32 s57, s57, 1
s_cmp_gt_u32 s57, 4194304
s_cbranch_scc1 L_back46
s_branch L_spin46
L_spin48:
ds_read_b32 v238, v236 offset:1536
s_waitcnt lgkmcnt(0)
v_cmp_ne_u32 vcc, 1, v238
s_nop 1
s_cbranch_vccz L_back48

s_add_u32 s57, s57, 1
s_cmp_gt_u32 s57, 4194304
s_cbranch_scc1 L_back48
s_branch L_spin48
L_spin49:
ds_read_b32 v238, v236 offset:1568
s_waitcnt lgkmcnt(0)
v_cmp_ne_u32 vcc, 1, v238
s_nop 1
s_cbranch_vccz L_back49

s_add_u32 s57, s57, 1
s_cmp_gt_u32 s57, 4194304
s_cbranch_scc1 L_back49
s_branch L_spin49
L_spin50:
ds_read_b32 v238, v236 offset:1600
s_waitcnt lgkmcnt(0)
v_cmp_ne_u32 vcc, 1, v238
s_nop 1
s_cbranch_vccz L_back50

s_add_u32 s57, s57, 1
s_cmp_gt_u32 s57, 4194304
s_cbranch_scc1 L_back50
s_branch L_spin50
L_spin51:
ds_read_b32 v238, v236 offset:1632
s_waitcnt lgkmcnt(0)
v_cmp_ne_u32 vcc, 1, v238
s_nop 1
s_cbranch_vccz L_back51

s_add_u32 s57, s57, 1
s_cmp_gt_u32 s57, 4194304
s_cbranch_scc1 L_back51
s_branch L_spin51
L_spin53:
ds_read_b32 v238, v236 offset:1696
s_waitcnt lgkmcnt(0)
v_cmp_ne_u32 vcc, 1, v238
s_nop 1
s_cbranch_vccz L_back53

s_add_u32 s57, s57, 1
s_cmp_gt_u32 s57, 4194304
s_cbranch_scc1 L_back53
s_branch L_spin53
L_lead:
s_waitcnt vmcnt(5)
v_bfe_u32 v244, v244, 3, 8
v_bfe_u32 v245, v245, 3, 8
v_bfe_u32 v246, v246, 3, 8
s_mov_b32 s45, 0
L_scan:
v_cmp_eq_u32 vcc, s45, v244
v_cmp_eq_u32 s[46:47], s45, v245
v_cmp_eq_u32 s[84:85], s45, v246
s_nop 1
s_or_b64 vcc, vcc, s[46:47]
s_or_b64 vcc, vcc, s[84:85]
s_cbranch_vccz L_scandone
s_add_u32 s45, s45, 1
s_branch L_scan
L_scandone:
s_lshl_b32 s45, s45, 3
s_or_b32 s45, s45, 0x800
v_mov_b32 v252, s45
s_mov_b64 exec, 1
buffer_store_dword v252, v235, s[40:43], s59 offen sc1
s_mov_b64 exec, -1
s_branch L_leadret
L_tagspin:
buffer_load_dword v253, v235, s[40:43], s59 offen sc1
s_waitcnt vmcnt(0)
v_cmp_eq_u32 vcc, 0, v253
s_nop 1
s_cbranch_vccz L_tagok
s_add_u32 s57, s57, 1
s_cmp_gt_u32 s57, 4194304
s_cbranch_scc1 L_tagok
s_branch L_tagspin
L_fslow:
buffer_load_dword v252, v251, s[32:35], 0 offen sc1
s_add_u32 s45, s56, 4
s_waitcnt vmcnt(0)
v_subrev_u32 v252, s45, v252
v_cmp_lt_u32 vcc, 3, v252
s_add_u32 s57, s57, 1
s_cmp_gt_u32 s57, 4194304
s_cbranch_scc1 L_fforce
s_cbranch_vccnz L_fsret
L_fforce:
s_bitset1_b32 s55, 31
L_fsret:
s_setpc_b64 s[92:93]
L_ownspin:
buffer_load_dword v252, v251, s[32:35], 0 offen offset:4 sc1
s_waitcnt vmcnt(0)
v_subrev_u32 v252, s45, v252
v_cmp_lt_u32 vcc, 6, v252
s_nop 1
s_cbranch_vccz L_ownok
s_add_u32 s57, s57, 1
s_cmp_gt_u32 s57, 4194304
s_cbranch_scc1 L_ownok
s_branch L_ownspin
.p2align 6
L_ones:
.fill 128, 4, 1
L_codeend:
.section .rodata,"a"
.p2align 6
.amdhsa_kernel concat_heads__mha_block_cached__gqa_block_cached__near_ridge_kernel
  .amdhsa_next_free_vgpr 256
  .amdhsa_next_free_sgpr 102
  .amdhsa_accum_offset 256
  .amdhsa_group_segment_fixed_size 0
  .amdhsa_kernarg_size 104
  .amdhsa_user_sgpr_count 2
  .amdhsa_user_sgpr_kernarg_segment_ptr 1
  .amdhsa_system_sgpr_workgroup_id_x 1
  .amdhsa_float_denorm_mode_32 3
.end_amdhsa_kernel
```
